```python
import torch

def _softmax(x, axis=-1):
    return torch.softmax(x, dim=axis)
def _gelu(x):
    return torch.nn.functional.gelu(x, approximate="tanh")
def _silu(x):
    return torch.nn.functional.silu(x)
def _sigmoid(x):
    return torch.sigmoid(x)
def _layernorm(x, axis=-1, eps=1e-5):
    m = x.mean(dim=axis, keepdim=True)
    v = x.var(dim=axis, keepdim=True, unbiased=False)
    return (x - m) / torch.sqrt(v + eps)
def _scatter_add(tgt, idx, src, axis=0):
    return tgt.clone().index_add_(axis, idx, src)
def _segment_sum(src, seg, n):
    out = torch.zeros((n,) + src.shape[1:], dtype=src.dtype)
    return out.index_add_(0, seg, src)
def _pad(x, pw):
    flat = tuple(v for pair in reversed(pw) for v in pair)
    return torch.nn.functional.pad(x, flat)

kernel_name = 'recurrent_scan__spectral_gfnet__glu_gated_geglu__prompt'

def setup_inputs():

    _w = (lambda a: (lambda t: t.to(torch.bfloat16) if t.is_floating_point() else t)(torch.as_tensor(a)))
    def _A_setup():
        B, S, D = 1, 2048, 512
        Df = D // 2 + 1
        return {
            "x": _w((lambda *s: torch.randn(*s, dtype=torch.bfloat16) * 0.1)(B, S, D)),
            "w_r": _w((lambda *s: torch.randn(*s, dtype=torch.bfloat16) * 3.2)(S, Df) * 0.02),
            "w_i": _w((lambda *s: torch.randn(*s, dtype=torch.bfloat16) * 3.2)(S, Df) * 0.02),
        }
    _A_in = _A_setup()

    def _B_setup():
        B, S, Dm, Df = 1, 2048, 512, 1376
        return {
            "x": _w((lambda *s: torch.randn(*s, dtype=torch.bfloat16) * 0.1)(B, S, Dm)),
            "w_gate": _w((lambda *s: torch.randn(*s, dtype=torch.bfloat16) * 0.8)(Dm, Df) * (Dm ** -0.5)),
            "w_up": _w((lambda *s: torch.randn(*s, dtype=torch.bfloat16) * 0.8)(Dm, Df) * (Dm ** -0.5)),
            "w_down": _w((lambda *s: torch.randn(*s, dtype=torch.bfloat16) * 0.8)(Df, Dm) * (Df ** -0.5)),
        }
    _B_in = _B_setup()

    return {
        "A_x": _A_in["x"],
        "A_w_r": _A_in["w_r"],
        "A_w_i": _A_in["w_i"],
        "B_x": _B_in["x"],
        "B_w_gate": _B_in["w_gate"],
        "B_w_up": _B_in["w_up"],
        "B_w_down": _B_in["w_down"],
    }

def reference(A_x, A_w_r, A_w_i, B_x, B_w_gate, B_w_up, B_w_down):
    def _A_ref(x, w_r, w_i):
        B, S, D = x.shape
        X = (lambda x, axes=(-2,-1): torch.fft.rfft2(x.float(), dim=axes))(x, axes=(-2, -1))
        W = w_r + 1j * w_i
        X = X * W
        y = (lambda x, s, axes=(-2,-1): torch.fft.irfft2(x, s=s, dim=axes).to(torch.bfloat16))(X, (S, D), axes=(-2, -1))
        return y

    def _B_ref(x, w_gate, w_up, w_down):
        g = torch.einsum("bsd,df->bsf", x, w_gate)
        u = torch.einsum("bsd,df->bsf", x, w_up)
        h = _gelu(g) * u
        return torch.einsum("bsf,fd->bsd", h, w_down)

    x = A_x
    xn = _layernorm(x, axis=-1)
    s = _A_ref(xn, A_w_r, A_w_i)
    g = _silu(_B_ref(xn, B_w_gate, B_w_up, B_w_down))
    return x + s * g
```

```asm
; @launch kernel=m_kernel grid=(256,1,1) block=(768,1,1) lds=163840
.amdgcn_target "amdgcn-amd-amdhsa--gfx950"
.text
.globl m_kernel
.p2align 8
.type m_kernel,@function
m_kernel:
    s_cmp_ge_u32 s2, 256
    s_cbranch_scc1 M_END
    s_load_dwordx16 s[32:47], s[0:1], 0
    s_load_dwordx4 s[48:51], s[0:1], 64
    v_and_b32 v1, 63, v0
    v_lshrrev_b32 v2, 6, v0
    s_nop 0
    v_readfirstlane_b32 s25, v2
    v_and_b32 v0, 255, v0
    s_mov_b32 s26, 0x3f3504f3
    s_mov_b32 s27, 0x3f3504f3
    s_and_b32 s24, s25, 3
    s_and_b32 s30, s2, 1
    s_lshl_b32 s30, s30, 3
    s_bfe_u32 s52, s2, 0x30003
    s_add_u32 s30, s30, s52
    s_bfe_u32 s31, s2, 0x20001
    s_lshl_b32 s31, s31, 2
    s_bfe_u32 s52, s2, 0x20006
    s_xor_b32 s52, s52, 3
    s_add_u32 s31, s31, s52
    s_and_b32 s87, s30, 0
    s_cmp_ge_u32 s25, 8
    s_cbranch_scc1 M_M
    s_cmp_ge_u32 s25, 4
    s_cbranch_scc1 M_F
    s_setprio 3
    s_cmp_eq_u32 s31, 15
    s_cbranch_scc1 M_VSP
    s_lshl_b32 s54, s30, 17
    s_lshl_b32 s53, s24, 15
    s_add_u32 s54, s54, s53
    v_lshrrev_b32 v2, 3, v1
    v_and_b32 v4, 7, v1
    v_lshlrev_b32 v20, 10, v2
    v_lshl_add_u32 v20, v4, 4, v20
    v_add_u32 v21, 8192, v20
    v_add_u32 v22, 16384, v20
    v_add_u32 v23, 24576, v20
    s_add_u32 s88, s87, 0
    s_and_b32 s88, s88, 7
    s_lshl_b32 s88, s88, 7
    s_add_u32 s88, s88, s54
    s_add_u32 s89, s87, 1
    s_and_b32 s89, s89, 7
    s_lshl_b32 s89, s89, 7
    s_add_u32 s89, s89, s54
    s_add_u32 s90, s87, 2
    s_and_b32 s90, s90, 7
    s_lshl_b32 s90, s90, 7
    s_add_u32 s90, s90, s54
    s_add_u32 s91, s87, 3
    s_and_b32 s91, s91, 7
    s_lshl_b32 s91, s91, 7
    s_add_u32 s91, s91, s54
    s_add_u32 s92, s87, 4
    s_and_b32 s92, s92, 7
    s_lshl_b32 s92, s92, 7
    s_add_u32 s92, s92, s54
    s_add_u32 s93, s87, 5
    s_and_b32 s93, s93, 7
    s_lshl_b32 s93, s93, 7
    s_add_u32 s93, s93, s54
    s_add_u32 s94, s87, 6
    s_and_b32 s94, s94, 7
    s_lshl_b32 s94, s94, 7
    s_add_u32 s94, s94, s54
    s_add_u32 s95, s87, 7
    s_and_b32 s95, s95, 7
    s_lshl_b32 s95, s95, 7
    s_add_u32 s95, s95, s54
    s_barrier
    s_waitcnt lgkmcnt(0)
    s_mov_b32 s8, s32
    s_mov_b32 s9, s33
    s_mov_b32 s10, 0x200000
    s_mov_b32 s11, 0x00020000
    buffer_load_dwordx4 v[32:35], v20, s[8:11], s88 offen
    buffer_load_dwordx4 v[48:51], v20, s[8:11], s89 offen
    buffer_load_dwordx4 v[64:67], v20, s[8:11], s90 offen
    buffer_load_dwordx4 v[80:83], v20, s[8:11], s91 offen
    buffer_load_dwordx4 v[96:99], v20, s[8:11], s92 offen
    buffer_load_dwordx4 v[112:115], v20, s[8:11], s93 offen
    buffer_load_dwordx4 v[128:131], v20, s[8:11], s94 offen
    buffer_load_dwordx4 v[144:147], v20, s[8:11], s95 offen
    buffer_load_dwordx4 v[36:39], v21, s[8:11], s88 offen
    buffer_load_dwordx4 v[52:55], v21, s[8:11], s89 offen
    buffer_load_dwordx4 v[68:71], v21, s[8:11], s90 offen
    buffer_load_dwordx4 v[84:87], v21, s[8:11], s91 offen
    buffer_load_dwordx4 v[100:103], v21, s[8:11], s92 offen
    buffer_load_dwordx4 v[116:119], v21, s[8:11], s93 offen
    buffer_load_dwordx4 v[132:135], v21, s[8:11], s94 offen
    buffer_load_dwordx4 v[148:151], v21, s[8:11], s95 offen
    buffer_load_dwordx4 v[40:43], v22, s[8:11], s88 offen
    buffer_load_dwordx4 v[56:59], v22, s[8:11], s89 offen
    buffer_load_dwordx4 v[72:75], v22, s[8:11], s90 offen
    buffer_load_dwordx4 v[88:91], v22, s[8:11], s91 offen
    buffer_load_dwordx4 v[104:107], v22, s[8:11], s92 offen
    buffer_load_dwordx4 v[120:123], v22, s[8:11], s93 offen
    buffer_load_dwordx4 v[136:139], v22, s[8:11], s94 offen
    buffer_load_dwordx4 v[152:155], v22, s[8:11], s95 offen
    buffer_load_dwordx4 v[44:47], v23, s[8:11], s88 offen
    buffer_load_dwordx4 v[60:63], v23, s[8:11], s89 offen
    buffer_load_dwordx4 v[76:79], v23, s[8:11], s90 offen
    buffer_load_dwordx4 v[92:95], v23, s[8:11], s91 offen
    buffer_load_dwordx4 v[108:111], v23, s[8:11], s92 offen
    buffer_load_dwordx4 v[124:127], v23, s[8:11], s93 offen
    buffer_load_dwordx4 v[140:143], v23, s[8:11], s94 offen
    buffer_load_dwordx4 v[156:159], v23, s[8:11], s95 offen
    s_lshl_b32 s52, s24, 12
    s_add_u32 s52, s52, 38144
    v_lshrrev_b32 v13, 4, v1
    v_xor_b32 v13, v13, v4
    v_lshlrev_b32 v13, 4, v13
    v_lshl_add_u32 v13, v2, 7, v13
    v_add_u32 v13, s52, v13
    v_xor_b32 v14, 64, v13
    s_and_b32 s53, s24, 2
    s_lshl_b32 s53, s53, 4
    v_add_u32 v2, 0, v1
    v_mul_u32_u24 v4, 43691, v2
    v_lshrrev_b32 v4, 19, v4
    v_lshlrev_b32 v2, 4, v2
    v_xor_b32 v2, s53, v2
    v_mul_u32_u24 v10, 2560, v4
    v_add_u32 v10, v10, v2
    v_add_u32 v2, 64, v1
    v_mul_u32_u24 v4, 43691, v2
    v_lshrrev_b32 v4, 19, v4
    v_lshlrev_b32 v2, 4, v2
    v_xor_b32 v2, s53, v2
    v_mul_u32_u24 v11, 2560, v4
    v_add_u32 v11, v11, v2
    v_add_u32 v2, 128, v1
    v_mul_u32_u24 v4, 43691, v2
    v_lshrrev_b32 v4, 19, v4
    v_lshlrev_b32 v2, 4, v2
    v_xor_b32 v2, s53, v2
    v_mul_u32_u24 v12, 2560, v4
    v_add_u32 v12, v12, v2
    s_and_b32 s53, s24, 1
    s_mul_i32 s56, s53, 44032
    s_mul_i32 s52, s31, 192
    s_add_u32 s56, s56, s52
    s_cmp_lt_u32 s24, 2
    s_cselect_b32 s64, s40, s42
    s_cselect_b32 s65, s41, s43
    s_mov_b32 s66, 0x158000
    s_mov_b32 s67, 0x00020000
    s_mul_i32 s55, s24, 3072
    s_add_u32 s55, s55, 87296
    s_lshl_b32 s52, s24, 8
    s_add_u32 s52, s52, 35008
    v_lshlrev_b32 v7, 2, v1
    v_add_u32 v7, s52, v7
    v_and_b32 v8, 3, v1
    v_mul_u32_u24 v8, 260, v8
    v_add_u32 v8, 36032, v8
    s_mov_b32 s61, 0xffff0000
    s_mov_b32 s62, 0x3f803f80
    s_mov_b32 s60, 0x00003f80
    s_mov_b32 s63, 0x3f800000
    s_setprio 3
    v_mov_b32 v16, 0
    v_mov_b32 v17, 0
    v_mov_b32 v18, 0
    v_mov_b32 v19, 0
    s_waitcnt vmcnt(31)
    v_dot2c_f32_bf16 v16, s62, v32
    v_dot2c_f32_bf16 v18, v32, v32
    v_dot2c_f32_bf16 v17, s62, v33
    v_dot2c_f32_bf16 v19, v33, v33
    v_dot2c_f32_bf16 v16, s62, v34
    v_dot2c_f32_bf16 v18, v34, v34
    v_dot2c_f32_bf16 v17, s62, v35
    v_dot2c_f32_bf16 v19, v35, v35
    s_waitcnt vmcnt(30)
    v_dot2c_f32_bf16 v16, s62, v48
    v_dot2c_f32_bf16 v18, v48, v48
    v_dot2c_f32_bf16 v17, s62, v49
    v_dot2c_f32_bf16 v19, v49, v49
    v_dot2c_f32_bf16 v16, s62, v50
    v_dot2c_f32_bf16 v18, v50, v50
    v_dot2c_f32_bf16 v17, s62, v51
    v_dot2c_f32_bf16 v19, v51, v51
    s_waitcnt vmcnt(29)
    v_dot2c_f32_bf16 v16, s62, v64
    v_dot2c_f32_bf16 v18, v64, v64
    v_dot2c_f32_bf16 v17, s62, v65
    v_dot2c_f32_bf16 v19, v65, v65
    v_dot2c_f32_bf16 v16, s62, v66
    v_dot2c_f32_bf16 v18, v66, v66
    v_dot2c_f32_bf16 v17, s62, v67
    v_dot2c_f32_bf16 v19, v67, v67
    s_waitcnt vmcnt(28)
    v_dot2c_f32_bf16 v16, s62, v80
    v_dot2c_f32_bf16 v18, v80, v80
    v_dot2c_f32_bf16 v17, s62, v81
    v_dot2c_f32_bf16 v19, v81, v81
    v_dot2c_f32_bf16 v16, s62, v82
    v_dot2c_f32_bf16 v18, v82, v82
    v_dot2c_f32_bf16 v17, s62, v83
    v_dot2c_f32_bf16 v19, v83, v83
    s_waitcnt vmcnt(27)
    v_dot2c_f32_bf16 v16, s62, v96
    v_dot2c_f32_bf16 v18, v96, v96
    v_dot2c_f32_bf16 v17, s62, v97
    v_dot2c_f32_bf16 v19, v97, v97
    v_dot2c_f32_bf16 v16, s62, v98
    v_dot2c_f32_bf16 v18, v98, v98
    v_dot2c_f32_bf16 v17, s62, v99
    v_dot2c_f32_bf16 v19, v99, v99
    s_waitcnt vmcnt(26)
    v_dot2c_f32_bf16 v16, s62, v112
    v_dot2c_f32_bf16 v18, v112, v112
    v_dot2c_f32_bf16 v17, s62, v113
    v_dot2c_f32_bf16 v19, v113, v113
    v_dot2c_f32_bf16 v16, s62, v114
    v_dot2c_f32_bf16 v18, v114, v114
    v_dot2c_f32_bf16 v17, s62, v115
    v_dot2c_f32_bf16 v19, v115, v115
    s_waitcnt vmcnt(25)
    v_dot2c_f32_bf16 v16, s62, v128
    v_dot2c_f32_bf16 v18, v128, v128
    v_dot2c_f32_bf16 v17, s62, v129
    v_dot2c_f32_bf16 v19, v129, v129
    v_dot2c_f32_bf16 v16, s62, v130
    v_dot2c_f32_bf16 v18, v130, v130
    v_dot2c_f32_bf16 v17, s62, v131
    v_dot2c_f32_bf16 v19, v131, v131
    s_waitcnt vmcnt(24)
    v_dot2c_f32_bf16 v16, s62, v144
    v_dot2c_f32_bf16 v18, v144, v144
    v_dot2c_f32_bf16 v17, s62, v145
    v_dot2c_f32_bf16 v19, v145, v145
    v_dot2c_f32_bf16 v16, s62, v146
    v_dot2c_f32_bf16 v18, v146, v146
    v_dot2c_f32_bf16 v17, s62, v147
    v_dot2c_f32_bf16 v19, v147, v147
    s_nop 1
    v_add_f32 v16, v16, v17
    v_add_f32 v18, v18, v19
    s_nop 0
    v_add_f32_dpp v16, v16, v16 quad_perm:[1,0,3,2] row_mask:0xf bank_mask:0xf
    v_add_f32_dpp v18, v18, v18 quad_perm:[1,0,3,2] row_mask:0xf bank_mask:0xf
    s_nop 0
    v_add_f32_dpp v16, v16, v16 quad_perm:[2,3,0,1] row_mask:0xf bank_mask:0xf
    v_add_f32_dpp v18, v18, v18 quad_perm:[2,3,0,1] row_mask:0xf bank_mask:0xf
    s_nop 0
    v_add_f32_dpp v16, v16, v16 row_half_mirror row_mask:0xf bank_mask:0xf
    v_add_f32_dpp v18, v18, v18 row_half_mirror row_mask:0xf bank_mask:0xf
    v_mul_f32 v16, 0x3b000000, v16
    v_mul_f32 v18, 0x3b000000, v18
    v_fma_f32 v18, -v16, v16, v18
    v_cvt_pk_bf16_f32 v160, 0, -v16
    v_cvt_pk_bf16_f32 v18, 0, v18
    v_add_f32 v18, 0x3727c5ac, v18
    v_cvt_pk_bf16_f32 v18, 0, v18
    v_sqrt_f32 v18, v18
    s_nop 0
    v_cvt_pk_bf16_f32 v18, 0, v18
    v_rcp_f32 v161, v18
    v_lshlrev_b32 v20, 16, v32
    v_and_b32 v21, s61, v32
    v_lshlrev_b32 v22, 16, v33
    v_and_b32 v23, s61, v33
    v_lshlrev_b32 v24, 16, v34
    v_and_b32 v25, s61, v34
    v_lshlrev_b32 v26, 16, v35
    v_and_b32 v27, s61, v35
    v_add_f32 v20, v20, v160
    v_add_f32 v21, v21, v160
    v_add_f32 v22, v22, v160
    v_add_f32 v23, v23, v160
    v_add_f32 v24, v24, v160
    v_add_f32 v25, v25, v160
    v_add_f32 v26, v26, v160
    v_add_f32 v27, v27, v160
    v_cvt_pk_bf16_f32 v20, 0, v20
    v_cvt_pk_bf16_f32 v21, 0, v21
    v_cvt_pk_bf16_f32 v22, 0, v22
    v_cvt_pk_bf16_f32 v23, 0, v23
    v_cvt_pk_bf16_f32 v24, 0, v24
    v_cvt_pk_bf16_f32 v25, 0, v25
    v_cvt_pk_bf16_f32 v26, 0, v26
    v_cvt_pk_bf16_f32 v27, 0, v27
    v_mul_f32 v20, v20, v161
    v_mul_f32 v21, v21, v161
    v_mul_f32 v22, v22, v161
    v_mul_f32 v23, v23, v161
    v_mul_f32 v24, v24, v161
    v_mul_f32 v25, v25, v161
    v_mul_f32 v26, v26, v161
    v_mul_f32 v27, v27, v161
    v_cvt_pk_bf16_f32 v32, v20, v21
    v_cvt_pk_bf16_f32 v33, v22, v23
    v_cvt_pk_bf16_f32 v34, v24, v25
    v_cvt_pk_bf16_f32 v35, v26, v27
    ds_write_b128 v13, v[32:35] offset:0
    v_mov_b32 v16, 0
    v_mov_b32 v17, 0
    v_mov_b32 v18, 0
    v_mov_b32 v19, 0
    s_waitcnt vmcnt(23)
    v_dot2c_f32_bf16 v16, s62, v36
    v_dot2c_f32_bf16 v18, v36, v36
    v_dot2c_f32_bf16 v17, s62, v37
    v_dot2c_f32_bf16 v19, v37, v37
    v_dot2c_f32_bf16 v16, s62, v38
    v_dot2c_f32_bf16 v18, v38, v38
    v_dot2c_f32_bf16 v17, s62, v39
    v_dot2c_f32_bf16 v19, v39, v39
    s_waitcnt vmcnt(22)
    v_dot2c_f32_bf16 v16, s62, v52
    v_dot2c_f32_bf16 v18, v52, v52
    v_dot2c_f32_bf16 v17, s62, v53
    v_dot2c_f32_bf16 v19, v53, v53
    v_dot2c_f32_bf16 v16, s62, v54
    v_dot2c_f32_bf16 v18, v54, v54
    v_dot2c_f32_bf16 v17, s62, v55
    v_dot2c_f32_bf16 v19, v55, v55
    s_waitcnt vmcnt(21)
    v_dot2c_f32_bf16 v16, s62, v68
    v_dot2c_f32_bf16 v18, v68, v68
    v_dot2c_f32_bf16 v17, s62, v69
    v_dot2c_f32_bf16 v19, v69, v69
    v_dot2c_f32_bf16 v16, s62, v70
    v_dot2c_f32_bf16 v18, v70, v70
    v_dot2c_f32_bf16 v17, s62, v71
    v_dot2c_f32_bf16 v19, v71, v71
    s_waitcnt vmcnt(20)
    v_dot2c_f32_bf16 v16, s62, v84
    v_dot2c_f32_bf16 v18, v84, v84
    v_dot2c_f32_bf16 v17, s62, v85
    v_dot2c_f32_bf16 v19, v85, v85
    v_dot2c_f32_bf16 v16, s62, v86
    v_dot2c_f32_bf16 v18, v86, v86
    v_dot2c_f32_bf16 v17, s62, v87
    v_dot2c_f32_bf16 v19, v87, v87
    s_waitcnt vmcnt(19)
    v_dot2c_f32_bf16 v16, s62, v100
    v_dot2c_f32_bf16 v18, v100, v100
    v_dot2c_f32_bf16 v17, s62, v101
    v_dot2c_f32_bf16 v19, v101, v101
    v_dot2c_f32_bf16 v16, s62, v102
    v_dot2c_f32_bf16 v18, v102, v102
    v_dot2c_f32_bf16 v17, s62, v103
    v_dot2c_f32_bf16 v19, v103, v103
    s_waitcnt vmcnt(18)
    v_dot2c_f32_bf16 v16, s62, v116
    v_dot2c_f32_bf16 v18, v116, v116
    v_dot2c_f32_bf16 v17, s62, v117
    v_dot2c_f32_bf16 v19, v117, v117
    v_dot2c_f32_bf16 v16, s62, v118
    v_dot2c_f32_bf16 v18, v118, v118
    v_dot2c_f32_bf16 v17, s62, v119
    v_dot2c_f32_bf16 v19, v119, v119
    s_waitcnt vmcnt(17)
    v_dot2c_f32_bf16 v16, s62, v132
    v_dot2c_f32_bf16 v18, v132, v132
    v_dot2c_f32_bf16 v17, s62, v133
    v_dot2c_f32_bf16 v19, v133, v133
    v_dot2c_f32_bf16 v16, s62, v134
    v_dot2c_f32_bf16 v18, v134, v134
    v_dot2c_f32_bf16 v17, s62, v135
    v_dot2c_f32_bf16 v19, v135, v135
    s_waitcnt vmcnt(16)
    v_dot2c_f32_bf16 v16, s62, v148
    v_dot2c_f32_bf16 v18, v148, v148
    v_dot2c_f32_bf16 v17, s62, v149
    v_dot2c_f32_bf16 v19, v149, v149
    v_dot2c_f32_bf16 v16, s62, v150
    v_dot2c_f32_bf16 v18, v150, v150
    v_dot2c_f32_bf16 v17, s62, v151
    v_dot2c_f32_bf16 v19, v151, v151
    s_nop 1
    v_add_f32 v16, v16, v17
    v_add_f32 v18, v18, v19
    s_nop 0
    v_add_f32_dpp v16, v16, v16 quad_perm:[1,0,3,2] row_mask:0xf bank_mask:0xf
    v_add_f32_dpp v18, v18, v18 quad_perm:[1,0,3,2] row_mask:0xf bank_mask:0xf
    s_nop 0
    v_add_f32_dpp v16, v16, v16 quad_perm:[2,3,0,1] row_mask:0xf bank_mask:0xf
    v_add_f32_dpp v18, v18, v18 quad_perm:[2,3,0,1] row_mask:0xf bank_mask:0xf
    s_nop 0
    v_add_f32_dpp v16, v16, v16 row_half_mirror row_mask:0xf bank_mask:0xf
    v_add_f32_dpp v18, v18, v18 row_half_mirror row_mask:0xf bank_mask:0xf
    v_mul_f32 v16, 0x3b000000, v16
    v_mul_f32 v18, 0x3b000000, v18
    v_fma_f32 v18, -v16, v16, v18
    v_cvt_pk_bf16_f32 v162, 0, -v16
    v_cvt_pk_bf16_f32 v18, 0, v18
    v_add_f32 v18, 0x3727c5ac, v18
    v_cvt_pk_bf16_f32 v18, 0, v18
    v_sqrt_f32 v18, v18
    s_nop 0
    v_cvt_pk_bf16_f32 v18, 0, v18
    v_rcp_f32 v163, v18
    v_lshlrev_b32 v20, 16, v36
    v_and_b32 v21, s61, v36
    v_lshlrev_b32 v22, 16, v37
    v_and_b32 v23, s61, v37
    v_lshlrev_b32 v24, 16, v38
    v_and_b32 v25, s61, v38
    v_lshlrev_b32 v26, 16, v39
    v_and_b32 v27, s61, v39
    v_add_f32 v20, v20, v162
    v_add_f32 v21, v21, v162
    v_add_f32 v22, v22, v162
    v_add_f32 v23, v23, v162
    v_add_f32 v24, v24, v162
    v_add_f32 v25, v25, v162
    v_add_f32 v26, v26, v162
    v_add_f32 v27, v27, v162
    v_cvt_pk_bf16_f32 v20, 0, v20
    v_cvt_pk_bf16_f32 v21, 0, v21
    v_cvt_pk_bf16_f32 v22, 0, v22
    v_cvt_pk_bf16_f32 v23, 0, v23
    v_cvt_pk_bf16_f32 v24, 0, v24
    v_cvt_pk_bf16_f32 v25, 0, v25
    v_cvt_pk_bf16_f32 v26, 0, v26
    v_cvt_pk_bf16_f32 v27, 0, v27
    v_mul_f32 v20, v20, v163
    v_mul_f32 v21, v21, v163
    v_mul_f32 v22, v22, v163
    v_mul_f32 v23, v23, v163
    v_mul_f32 v24, v24, v163
    v_mul_f32 v25, v25, v163
    v_mul_f32 v26, v26, v163
    v_mul_f32 v27, v27, v163
    v_cvt_pk_bf16_f32 v36, v20, v21
    v_cvt_pk_bf16_f32 v37, v22, v23
    v_cvt_pk_bf16_f32 v38, v24, v25
    v_cvt_pk_bf16_f32 v39, v26, v27
    ds_write_b128 v14, v[36:39] offset:1024
    v_mov_b32 v16, 0
    v_mov_b32 v17, 0
    v_mov_b32 v18, 0
    v_mov_b32 v19, 0
    s_waitcnt vmcnt(15)
    v_dot2c_f32_bf16 v16, s62, v40
    v_dot2c_f32_bf16 v18, v40, v40
    v_dot2c_f32_bf16 v17, s62, v41
    v_dot2c_f32_bf16 v19, v41, v41
    v_dot2c_f32_bf16 v16, s62, v42
    v_dot2c_f32_bf16 v18, v42, v42
    v_dot2c_f32_bf16 v17, s62, v43
    v_dot2c_f32_bf16 v19, v43, v43
    s_waitcnt vmcnt(14)
    v_dot2c_f32_bf16 v16, s62, v56
    v_dot2c_f32_bf16 v18, v56, v56
    v_dot2c_f32_bf16 v17, s62, v57
    v_dot2c_f32_bf16 v19, v57, v57
    v_dot2c_f32_bf16 v16, s62, v58
    v_dot2c_f32_bf16 v18, v58, v58
    v_dot2c_f32_bf16 v17, s62, v59
    v_dot2c_f32_bf16 v19, v59, v59
    s_waitcnt vmcnt(13)
    v_dot2c_f32_bf16 v16, s62, v72
    v_dot2c_f32_bf16 v18, v72, v72
    v_dot2c_f32_bf16 v17, s62, v73
    v_dot2c_f32_bf16 v19, v73, v73
    v_dot2c_f32_bf16 v16, s62, v74
    v_dot2c_f32_bf16 v18, v74, v74
    v_dot2c_f32_bf16 v17, s62, v75
    v_dot2c_f32_bf16 v19, v75, v75
    s_waitcnt vmcnt(12)
    v_dot2c_f32_bf16 v16, s62, v88
    v_dot2c_f32_bf16 v18, v88, v88
    v_dot2c_f32_bf16 v17, s62, v89
    v_dot2c_f32_bf16 v19, v89, v89
    v_dot2c_f32_bf16 v16, s62, v90
    v_dot2c_f32_bf16 v18, v90, v90
    v_dot2c_f32_bf16 v17, s62, v91
    v_dot2c_f32_bf16 v19, v91, v91
    s_waitcnt vmcnt(11)
    v_dot2c_f32_bf16 v16, s62, v104
    v_dot2c_f32_bf16 v18, v104, v104
    v_dot2c_f32_bf16 v17, s62, v105
    v_dot2c_f32_bf16 v19, v105, v105
    v_dot2c_f32_bf16 v16, s62, v106
    v_dot2c_f32_bf16 v18, v106, v106
    v_dot2c_f32_bf16 v17, s62, v107
    v_dot2c_f32_bf16 v19, v107, v107
    s_waitcnt vmcnt(10)
    v_dot2c_f32_bf16 v16, s62, v120
    v_dot2c_f32_bf16 v18, v120, v120
    v_dot2c_f32_bf16 v17, s62, v121
    v_dot2c_f32_bf16 v19, v121, v121
    v_dot2c_f32_bf16 v16, s62, v122
    v_dot2c_f32_bf16 v18, v122, v122
    v_dot2c_f32_bf16 v17, s62, v123
    v_dot2c_f32_bf16 v19, v123, v123
    s_waitcnt vmcnt(9)
    v_dot2c_f32_bf16 v16, s62, v136
    v_dot2c_f32_bf16 v18, v136, v136
    v_dot2c_f32_bf16 v17, s62, v137
    v_dot2c_f32_bf16 v19, v137, v137
    v_dot2c_f32_bf16 v16, s62, v138
    v_dot2c_f32_bf16 v18, v138, v138
    v_dot2c_f32_bf16 v17, s62, v139
    v_dot2c_f32_bf16 v19, v139, v139
    s_waitcnt vmcnt(8)
    v_dot2c_f32_bf16 v16, s62, v152
    v_dot2c_f32_bf16 v18, v152, v152
    v_dot2c_f32_bf16 v17, s62, v153
    v_dot2c_f32_bf16 v19, v153, v153
    v_dot2c_f32_bf16 v16, s62, v154
    v_dot2c_f32_bf16 v18, v154, v154
    v_dot2c_f32_bf16 v17, s62, v155
    v_dot2c_f32_bf16 v19, v155, v155
    s_nop 1
    v_add_f32 v16, v16, v17
    v_add_f32 v18, v18, v19
    s_nop 0
    v_add_f32_dpp v16, v16, v16 quad_perm:[1,0,3,2] row_mask:0xf bank_mask:0xf
    v_add_f32_dpp v18, v18, v18 quad_perm:[1,0,3,2] row_mask:0xf bank_mask:0xf
    s_nop 0
    v_add_f32_dpp v16, v16, v16 quad_perm:[2,3,0,1] row_mask:0xf bank_mask:0xf
    v_add_f32_dpp v18, v18, v18 quad_perm:[2,3,0,1] row_mask:0xf bank_mask:0xf
    s_nop 0
    v_add_f32_dpp v16, v16, v16 row_half_mirror row_mask:0xf bank_mask:0xf
    v_add_f32_dpp v18, v18, v18 row_half_mirror row_mask:0xf bank_mask:0xf
    v_mul_f32 v16, 0x3b000000, v16
    v_mul_f32 v18, 0x3b000000, v18
    v_fma_f32 v18, -v16, v16, v18
    v_cvt_pk_bf16_f32 v164, 0, -v16
    v_cvt_pk_bf16_f32 v18, 0, v18
    v_add_f32 v18, 0x3727c5ac, v18
    v_cvt_pk_bf16_f32 v18, 0, v18
    v_sqrt_f32 v18, v18
    s_nop 0
    v_cvt_pk_bf16_f32 v18, 0, v18
    v_rcp_f32 v165, v18
    v_lshlrev_b32 v20, 16, v40
    v_and_b32 v21, s61, v40
    v_lshlrev_b32 v22, 16, v41
    v_and_b32 v23, s61, v41
    v_lshlrev_b32 v24, 16, v42
    v_and_b32 v25, s61, v42
    v_lshlrev_b32 v26, 16, v43
    v_and_b32 v27, s61, v43
    v_add_f32 v20, v20, v164
    v_add_f32 v21, v21, v164
    v_add_f32 v22, v22, v164
    v_add_f32 v23, v23, v164
    v_add_f32 v24, v24, v164
    v_add_f32 v25, v25, v164
    v_add_f32 v26, v26, v164
    v_add_f32 v27, v27, v164
    v_cvt_pk_bf16_f32 v20, 0, v20
    v_cvt_pk_bf16_f32 v21, 0, v21
    v_cvt_pk_bf16_f32 v22, 0, v22
    v_cvt_pk_bf16_f32 v23, 0, v23
    v_cvt_pk_bf16_f32 v24, 0, v24
    v_cvt_pk_bf16_f32 v25, 0, v25
    v_cvt_pk_bf16_f32 v26, 0, v26
    v_cvt_pk_bf16_f32 v27, 0, v27
    v_mul_f32 v20, v20, v165
    v_mul_f32 v21, v21, v165
    v_mul_f32 v22, v22, v165
    v_mul_f32 v23, v23, v165
    v_mul_f32 v24, v24, v165
    v_mul_f32 v25, v25, v165
    v_mul_f32 v26, v26, v165
    v_mul_f32 v27, v27, v165
    v_cvt_pk_bf16_f32 v40, v20, v21
    v_cvt_pk_bf16_f32 v41, v22, v23
    v_cvt_pk_bf16_f32 v42, v24, v25
    v_cvt_pk_bf16_f32 v43, v26, v27
    ds_write_b128 v13, v[40:43] offset:2048
    v_mov_b32 v16, 0
    v_mov_b32 v17, 0
    v_mov_b32 v18, 0
    v_mov_b32 v19, 0
    s_waitcnt vmcnt(7)
    v_dot2c_f32_bf16 v16, s62, v44
    v_dot2c_f32_bf16 v18, v44, v44
    v_dot2c_f32_bf16 v17, s62, v45
    v_dot2c_f32_bf16 v19, v45, v45
    v_dot2c_f32_bf16 v16, s62, v46
    v_dot2c_f32_bf16 v18, v46, v46
    v_dot2c_f32_bf16 v17, s62, v47
    v_dot2c_f32_bf16 v19, v47, v47
    s_waitcnt vmcnt(6)
    v_dot2c_f32_bf16 v16, s62, v60
    v_dot2c_f32_bf16 v18, v60, v60
    v_dot2c_f32_bf16 v17, s62, v61
    v_dot2c_f32_bf16 v19, v61, v61
    v_dot2c_f32_bf16 v16, s62, v62
    v_dot2c_f32_bf16 v18, v62, v62
    v_dot2c_f32_bf16 v17, s62, v63
    v_dot2c_f32_bf16 v19, v63, v63
    s_waitcnt vmcnt(5)
    v_dot2c_f32_bf16 v16, s62, v76
    v_dot2c_f32_bf16 v18, v76, v76
    v_dot2c_f32_bf16 v17, s62, v77
    v_dot2c_f32_bf16 v19, v77, v77
    v_dot2c_f32_bf16 v16, s62, v78
    v_dot2c_f32_bf16 v18, v78, v78
    v_dot2c_f32_bf16 v17, s62, v79
    v_dot2c_f32_bf16 v19, v79, v79
    s_waitcnt vmcnt(4)
    v_dot2c_f32_bf16 v16, s62, v92
    v_dot2c_f32_bf16 v18, v92, v92
    v_dot2c_f32_bf16 v17, s62, v93
    v_dot2c_f32_bf16 v19, v93, v93
    v_dot2c_f32_bf16 v16, s62, v94
    v_dot2c_f32_bf16 v18, v94, v94
    v_dot2c_f32_bf16 v17, s62, v95
    v_dot2c_f32_bf16 v19, v95, v95
    s_waitcnt vmcnt(3)
    v_dot2c_f32_bf16 v16, s62, v108
    v_dot2c_f32_bf16 v18, v108, v108
    v_dot2c_f32_bf16 v17, s62, v109
    v_dot2c_f32_bf16 v19, v109, v109
    v_dot2c_f32_bf16 v16, s62, v110
    v_dot2c_f32_bf16 v18, v110, v110
    v_dot2c_f32_bf16 v17, s62, v111
    v_dot2c_f32_bf16 v19, v111, v111
    s_waitcnt vmcnt(2)
    v_dot2c_f32_bf16 v16, s62, v124
    v_dot2c_f32_bf16 v18, v124, v124
    v_dot2c_f32_bf16 v17, s62, v125
    v_dot2c_f32_bf16 v19, v125, v125
    v_dot2c_f32_bf16 v16, s62, v126
    v_dot2c_f32_bf16 v18, v126, v126
    v_dot2c_f32_bf16 v17, s62, v127
    v_dot2c_f32_bf16 v19, v127, v127
    s_waitcnt vmcnt(1)
    v_dot2c_f32_bf16 v16, s62, v140
    v_dot2c_f32_bf16 v18, v140, v140
    v_dot2c_f32_bf16 v17, s62, v141
    v_dot2c_f32_bf16 v19, v141, v141
    v_dot2c_f32_bf16 v16, s62, v142
    v_dot2c_f32_bf16 v18, v142, v142
    v_dot2c_f32_bf16 v17, s62, v143
    v_dot2c_f32_bf16 v19, v143, v143
    s_waitcnt vmcnt(0)
    v_dot2c_f32_bf16 v16, s62, v156
    v_dot2c_f32_bf16 v18, v156, v156
    v_dot2c_f32_bf16 v17, s62, v157
    v_dot2c_f32_bf16 v19, v157, v157
    v_dot2c_f32_bf16 v16, s62, v158
    v_dot2c_f32_bf16 v18, v158, v158
    v_dot2c_f32_bf16 v17, s62, v159
    v_dot2c_f32_bf16 v19, v159, v159
    s_nop 1
    v_add_f32 v16, v16, v17
    v_add_f32 v18, v18, v19
    s_nop 0
    v_add_f32_dpp v16, v16, v16 quad_perm:[1,0,3,2] row_mask:0xf bank_mask:0xf
    v_add_f32_dpp v18, v18, v18 quad_perm:[1,0,3,2] row_mask:0xf bank_mask:0xf
    s_nop 0
    v_add_f32_dpp v16, v16, v16 quad_perm:[2,3,0,1] row_mask:0xf bank_mask:0xf
    v_add_f32_dpp v18, v18, v18 quad_perm:[2,3,0,1] row_mask:0xf bank_mask:0xf
    s_nop 0
    v_add_f32_dpp v16, v16, v16 row_half_mirror row_mask:0xf bank_mask:0xf
    v_add_f32_dpp v18, v18, v18 row_half_mirror row_mask:0xf bank_mask:0xf
    v_mul_f32 v16, 0x3b000000, v16
    v_mul_f32 v18, 0x3b000000, v18
    v_fma_f32 v18, -v16, v16, v18
    v_cvt_pk_bf16_f32 v166, 0, -v16
    v_cvt_pk_bf16_f32 v18, 0, v18
    v_add_f32 v18, 0x3727c5ac, v18
    v_cvt_pk_bf16_f32 v18, 0, v18
    v_sqrt_f32 v18, v18
    s_nop 0
    v_cvt_pk_bf16_f32 v18, 0, v18
    v_rcp_f32 v167, v18
    v_lshlrev_b32 v20, 16, v44
    v_and_b32 v21, s61, v44
    v_lshlrev_b32 v22, 16, v45
    v_and_b32 v23, s61, v45
    v_lshlrev_b32 v24, 16, v46
    v_and_b32 v25, s61, v46
    v_lshlrev_b32 v26, 16, v47
    v_and_b32 v27, s61, v47
    v_add_f32 v20, v20, v166
    v_add_f32 v21, v21, v166
    v_add_f32 v22, v22, v166
    v_add_f32 v23, v23, v166
    v_add_f32 v24, v24, v166
    v_add_f32 v25, v25, v166
    v_add_f32 v26, v26, v166
    v_add_f32 v27, v27, v166
    v_cvt_pk_bf16_f32 v20, 0, v20
    v_cvt_pk_bf16_f32 v21, 0, v21
    v_cvt_pk_bf16_f32 v22, 0, v22
    v_cvt_pk_bf16_f32 v23, 0, v23
    v_cvt_pk_bf16_f32 v24, 0, v24
    v_cvt_pk_bf16_f32 v25, 0, v25
    v_cvt_pk_bf16_f32 v26, 0, v26
    v_cvt_pk_bf16_f32 v27, 0, v27
    v_mul_f32 v20, v20, v167
    v_mul_f32 v21, v21, v167
    v_mul_f32 v22, v22, v167
    v_mul_f32 v23, v23, v167
    v_mul_f32 v24, v24, v167
    v_mul_f32 v25, v25, v167
    v_mul_f32 v26, v26, v167
    v_mul_f32 v27, v27, v167
    v_cvt_pk_bf16_f32 v44, v20, v21
    v_cvt_pk_bf16_f32 v45, v22, v23
    v_cvt_pk_bf16_f32 v46, v24, v25
    v_cvt_pk_bf16_f32 v47, v26, v27
    ds_write_b128 v14, v[44:47] offset:3072
    v_mov_b32 v9, 2
    ds_write_b32 v7, v9
    s_wakeup
    v_lshlrev_b32 v20, 16, v48
    v_and_b32 v21, s61, v48
    v_lshlrev_b32 v22, 16, v49
    v_and_b32 v23, s61, v49
    v_lshlrev_b32 v24, 16, v50
    v_and_b32 v25, s61, v50
    v_lshlrev_b32 v26, 16, v51
    v_and_b32 v27, s61, v51
    v_add_f32 v20, v20, v160
    v_add_f32 v21, v21, v160
    v_add_f32 v22, v22, v160
    v_add_f32 v23, v23, v160
    v_add_f32 v24, v24, v160
    v_add_f32 v25, v25, v160
    v_add_f32 v26, v26, v160
    v_add_f32 v27, v27, v160
    v_cvt_pk_bf16_f32 v20, 0, v20
    v_cvt_pk_bf16_f32 v21, 0, v21
    v_cvt_pk_bf16_f32 v22, 0, v22
    v_cvt_pk_bf16_f32 v23, 0, v23
    v_cvt_pk_bf16_f32 v24, 0, v24
    v_cvt_pk_bf16_f32 v25, 0, v25
    v_cvt_pk_bf16_f32 v26, 0, v26
    v_cvt_pk_bf16_f32 v27, 0, v27
    v_mul_f32 v20, v20, v161
    v_mul_f32 v21, v21, v161
    v_mul_f32 v22, v22, v161
    v_mul_f32 v23, v23, v161
    v_mul_f32 v24, v24, v161
    v_mul_f32 v25, v25, v161
    v_mul_f32 v26, v26, v161
    v_mul_f32 v27, v27, v161
    v_cvt_pk_bf16_f32 v48, v20, v21
    v_cvt_pk_bf16_f32 v49, v22, v23
    v_cvt_pk_bf16_f32 v50, v24, v25
    v_cvt_pk_bf16_f32 v51, v26, v27
    ds_write_b128 v13, v[48:51] offset:16384
    v_lshlrev_b32 v20, 16, v52
    v_and_b32 v21, s61, v52
    v_lshlrev_b32 v22, 16, v53
    v_and_b32 v23, s61, v53
    v_lshlrev_b32 v24, 16, v54
    v_and_b32 v25, s61, v54
    v_lshlrev_b32 v26, 16, v55
    v_and_b32 v27, s61, v55
    v_add_f32 v20, v20, v162
    v_add_f32 v21, v21, v162
    v_add_f32 v22, v22, v162
    v_add_f32 v23, v23, v162
    v_add_f32 v24, v24, v162
    v_add_f32 v25, v25, v162
    v_add_f32 v26, v26, v162
    v_add_f32 v27, v27, v162
    v_cvt_pk_bf16_f32 v20, 0, v20
    v_cvt_pk_bf16_f32 v21, 0, v21
    v_cvt_pk_bf16_f32 v22, 0, v22
    v_cvt_pk_bf16_f32 v23, 0, v23
    v_cvt_pk_bf16_f32 v24, 0, v24
    v_cvt_pk_bf16_f32 v25, 0, v25
    v_cvt_pk_bf16_f32 v26, 0, v26
    v_cvt_pk_bf16_f32 v27, 0, v27
    v_mul_f32 v20, v20, v163
    v_mul_f32 v21, v21, v163
    v_mul_f32 v22, v22, v163
    v_mul_f32 v23, v23, v163
    v_mul_f32 v24, v24, v163
    v_mul_f32 v25, v25, v163
    v_mul_f32 v26, v26, v163
    v_mul_f32 v27, v27, v163
    v_cvt_pk_bf16_f32 v52, v20, v21
    v_cvt_pk_bf16_f32 v53, v22, v23
    v_cvt_pk_bf16_f32 v54, v24, v25
    v_cvt_pk_bf16_f32 v55, v26, v27
    ds_write_b128 v14, v[52:55] offset:17408
    v_lshlrev_b32 v20, 16, v56
    v_and_b32 v21, s61, v56
    v_lshlrev_b32 v22, 16, v57
    v_and_b32 v23, s61, v57
    v_lshlrev_b32 v24, 16, v58
    v_and_b32 v25, s61, v58
    v_lshlrev_b32 v26, 16, v59
    v_and_b32 v27, s61, v59
    v_add_f32 v20, v20, v164
    v_add_f32 v21, v21, v164
    v_add_f32 v22, v22, v164
    v_add_f32 v23, v23, v164
    v_add_f32 v24, v24, v164
    v_add_f32 v25, v25, v164
    v_add_f32 v26, v26, v164
    v_add_f32 v27, v27, v164
    v_cvt_pk_bf16_f32 v20, 0, v20
    v_cvt_pk_bf16_f32 v21, 0, v21
    v_cvt_pk_bf16_f32 v22, 0, v22
    v_cvt_pk_bf16_f32 v23, 0, v23
    v_cvt_pk_bf16_f32 v24, 0, v24
    v_cvt_pk_bf16_f32 v25, 0, v25
    v_cvt_pk_bf16_f32 v26, 0, v26
    v_cvt_pk_bf16_f32 v27, 0, v27
    v_mul_f32 v20, v20, v165
    v_mul_f32 v21, v21, v165
    v_mul_f32 v22, v22, v165
    v_mul_f32 v23, v23, v165
    v_mul_f32 v24, v24, v165
    v_mul_f32 v25, v25, v165
    v_mul_f32 v26, v26, v165
    v_mul_f32 v27, v27, v165
    v_cvt_pk_bf16_f32 v56, v20, v21
    v_cvt_pk_bf16_f32 v57, v22, v23
    v_cvt_pk_bf16_f32 v58, v24, v25
    v_cvt_pk_bf16_f32 v59, v26, v27
    ds_write_b128 v13, v[56:59] offset:18432
    v_lshlrev_b32 v20, 16, v60
    v_and_b32 v21, s61, v60
    v_lshlrev_b32 v22, 16, v61
    v_and_b32 v23, s61, v61
    v_lshlrev_b32 v24, 16, v62
    v_and_b32 v25, s61, v62
    v_lshlrev_b32 v26, 16, v63
    v_and_b32 v27, s61, v63
    v_add_f32 v20, v20, v166
    v_add_f32 v21, v21, v166
    v_add_f32 v22, v22, v166
    v_add_f32 v23, v23, v166
    v_add_f32 v24, v24, v166
    v_add_f32 v25, v25, v166
    v_add_f32 v26, v26, v166
    v_add_f32 v27, v27, v166
    v_cvt_pk_bf16_f32 v20, 0, v20
    v_cvt_pk_bf16_f32 v21, 0, v21
    v_cvt_pk_bf16_f32 v22, 0, v22
    v_cvt_pk_bf16_f32 v23, 0, v23
    v_cvt_pk_bf16_f32 v24, 0, v24
    v_cvt_pk_bf16_f32 v25, 0, v25
    v_cvt_pk_bf16_f32 v26, 0, v26
    v_cvt_pk_bf16_f32 v27, 0, v27
    v_mul_f32 v20, v20, v167
    v_mul_f32 v21, v21, v167
    v_mul_f32 v22, v22, v167
    v_mul_f32 v23, v23, v167
    v_mul_f32 v24, v24, v167
    v_mul_f32 v25, v25, v167
    v_mul_f32 v26, v26, v167
    v_mul_f32 v27, v27, v167
    v_cvt_pk_bf16_f32 v60, v20, v21
    v_cvt_pk_bf16_f32 v61, v22, v23
    v_cvt_pk_bf16_f32 v62, v24, v25
    v_cvt_pk_bf16_f32 v63, v26, v27
    ds_write_b128 v14, v[60:63] offset:19456
    s_add_u32 s88, s87, 1
    s_and_b32 s88, s88, 7
    s_mul_i32 s88, s88, 176128
    s_add_u32 s88, s88, s56
    s_add_u32 m0, s55, 24576
    s_nop 0
    buffer_load_dwordx4 v10, s[64:67], s88 offen lds
    s_add_u32 m0, s55, 25600
    s_nop 0
    buffer_load_dwordx4 v11, s[64:67], s88 offen lds
    s_add_u32 m0, s55, 26624
    s_nop 0
    buffer_load_dwordx4 v12, s[64:67], s88 offen lds
    s_add_u32 s88, s87, 1
    s_and_b32 s88, s88, 7
    s_mul_i32 s88, s88, 176128
    s_add_u32 s88, s88, s56
    s_add_u32 s88, s88, 88064
    s_add_u32 m0, s55, 36864
    s_nop 0
    buffer_load_dwordx4 v10, s[64:67], s88 offen lds
    s_add_u32 m0, s55, 37888
    s_nop 0
    buffer_load_dwordx4 v11, s[64:67], s88 offen lds
    s_add_u32 m0, s55, 38912
    s_nop 0
    buffer_load_dwordx4 v12, s[64:67], s88 offen lds
    s_add_u32 s88, s87, 2
    s_and_b32 s88, s88, 7
    s_mul_i32 s88, s88, 176128
    s_add_u32 s88, s88, s56
    s_add_u32 m0, s55, 49152
    s_nop 0
    buffer_load_dwordx4 v10, s[64:67], s88 offen lds
    s_add_u32 m0, s55, 50176
    s_nop 0
    buffer_load_dwordx4 v11, s[64:67], s88 offen lds
    s_add_u32 m0, s55, 51200
    s_nop 0
    buffer_load_dwordx4 v12, s[64:67], s88 offen lds
    s_add_u32 s88, s87, 2
    s_and_b32 s88, s88, 7
    s_mul_i32 s88, s88, 176128
    s_add_u32 s88, s88, s56
    s_add_u32 s88, s88, 88064
    s_add_u32 m0, s55, 61440
    s_nop 0
    buffer_load_dwordx4 v10, s[64:67], s88 offen lds
    s_add_u32 m0, s55, 62464
    s_nop 0
    buffer_load_dwordx4 v11, s[64:67], s88 offen lds
    s_add_u32 m0, s55, 63488
    s_nop 0
    buffer_load_dwordx4 v12, s[64:67], s88 offen lds
    s_setprio 0
    v_lshlrev_b32 v20, 16, v64
    v_and_b32 v21, s61, v64
    v_lshlrev_b32 v22, 16, v65
    v_and_b32 v23, s61, v65
    v_lshlrev_b32 v24, 16, v66
    v_and_b32 v25, s61, v66
    v_lshlrev_b32 v26, 16, v67
    v_and_b32 v27, s61, v67
    v_add_f32 v20, v20, v160
    v_add_f32 v21, v21, v160
    v_add_f32 v22, v22, v160
    v_add_f32 v23, v23, v160
    v_add_f32 v24, v24, v160
    v_add_f32 v25, v25, v160
    v_add_f32 v26, v26, v160
    v_add_f32 v27, v27, v160
    v_cvt_pk_bf16_f32 v20, 0, v20
    v_cvt_pk_bf16_f32 v21, 0, v21
    v_cvt_pk_bf16_f32 v22, 0, v22
    v_cvt_pk_bf16_f32 v23, 0, v23
    v_cvt_pk_bf16_f32 v24, 0, v24
    v_cvt_pk_bf16_f32 v25, 0, v25
    v_cvt_pk_bf16_f32 v26, 0, v26
    v_cvt_pk_bf16_f32 v27, 0, v27
    v_mul_f32 v20, v20, v161
    v_mul_f32 v21, v21, v161
    v_mul_f32 v22, v22, v161
    v_mul_f32 v23, v23, v161
    v_mul_f32 v24, v24, v161
    v_mul_f32 v25, v25, v161
    v_mul_f32 v26, v26, v161
    v_mul_f32 v27, v27, v161
    v_cvt_pk_bf16_f32 v64, v20, v21
    v_cvt_pk_bf16_f32 v65, v22, v23
    v_cvt_pk_bf16_f32 v66, v24, v25
    v_cvt_pk_bf16_f32 v67, v26, v27
    ds_write_b128 v13, v[64:67] offset:32768
    v_lshlrev_b32 v20, 16, v68
    v_and_b32 v21, s61, v68
    v_lshlrev_b32 v22, 16, v69
    v_and_b32 v23, s61, v69
    v_lshlrev_b32 v24, 16, v70
    v_and_b32 v25, s61, v70
    v_lshlrev_b32 v26, 16, v71
    v_and_b32 v27, s61, v71
    v_add_f32 v20, v20, v162
    v_add_f32 v21, v21, v162
    v_add_f32 v22, v22, v162
    v_add_f32 v23, v23, v162
    v_add_f32 v24, v24, v162
    v_add_f32 v25, v25, v162
    v_add_f32 v26, v26, v162
    v_add_f32 v27, v27, v162
    v_cvt_pk_bf16_f32 v20, 0, v20
    v_cvt_pk_bf16_f32 v21, 0, v21
    v_cvt_pk_bf16_f32 v22, 0, v22
    v_cvt_pk_bf16_f32 v23, 0, v23
    v_cvt_pk_bf16_f32 v24, 0, v24
    v_cvt_pk_bf16_f32 v25, 0, v25
    v_cvt_pk_bf16_f32 v26, 0, v26
    v_cvt_pk_bf16_f32 v27, 0, v27
    v_mul_f32 v20, v20, v163
    v_mul_f32 v21, v21, v163
    v_mul_f32 v22, v22, v163
    v_mul_f32 v23, v23, v163
    v_mul_f32 v24, v24, v163
    v_mul_f32 v25, v25, v163
    v_mul_f32 v26, v26, v163
    v_mul_f32 v27, v27, v163
    v_cvt_pk_bf16_f32 v68, v20, v21
    v_cvt_pk_bf16_f32 v69, v22, v23
    v_cvt_pk_bf16_f32 v70, v24, v25
    v_cvt_pk_bf16_f32 v71, v26, v27
    ds_write_b128 v14, v[68:71] offset:33792
    v_lshlrev_b32 v20, 16, v72
    v_and_b32 v21, s61, v72
    v_lshlrev_b32 v22, 16, v73
    v_and_b32 v23, s61, v73
    v_lshlrev_b32 v24, 16, v74
    v_and_b32 v25, s61, v74
    v_lshlrev_b32 v26, 16, v75
    v_and_b32 v27, s61, v75
    v_add_f32 v20, v20, v164
    v_add_f32 v21, v21, v164
    v_add_f32 v22, v22, v164
    v_add_f32 v23, v23, v164
    v_add_f32 v24, v24, v164
    v_add_f32 v25, v25, v164
    v_add_f32 v26, v26, v164
    v_add_f32 v27, v27, v164
    v_cvt_pk_bf16_f32 v20, 0, v20
    v_cvt_pk_bf16_f32 v21, 0, v21
    v_cvt_pk_bf16_f32 v22, 0, v22
    v_cvt_pk_bf16_f32 v23, 0, v23
    v_cvt_pk_bf16_f32 v24, 0, v24
    v_cvt_pk_bf16_f32 v25, 0, v25
    v_cvt_pk_bf16_f32 v26, 0, v26
    v_cvt_pk_bf16_f32 v27, 0, v27
    v_mul_f32 v20, v20, v165
    v_mul_f32 v21, v21, v165
    v_mul_f32 v22, v22, v165
    v_mul_f32 v23, v23, v165
    v_mul_f32 v24, v24, v165
    v_mul_f32 v25, v25, v165
    v_mul_f32 v26, v26, v165
    v_mul_f32 v27, v27, v165
    v_cvt_pk_bf16_f32 v72, v20, v21
    v_cvt_pk_bf16_f32 v73, v22, v23
    v_cvt_pk_bf16_f32 v74, v24, v25
    v_cvt_pk_bf16_f32 v75, v26, v27
    ds_write_b128 v13, v[72:75] offset:34816
    v_lshlrev_b32 v20, 16, v76
    v_and_b32 v21, s61, v76
    v_lshlrev_b32 v22, 16, v77
    v_and_b32 v23, s61, v77
    v_lshlrev_b32 v24, 16, v78
    v_and_b32 v25, s61, v78
    v_lshlrev_b32 v26, 16, v79
    v_and_b32 v27, s61, v79
    v_add_f32 v20, v20, v166
    v_add_f32 v21, v21, v166
    v_add_f32 v22, v22, v166
    v_add_f32 v23, v23, v166
    v_add_f32 v24, v24, v166
    v_add_f32 v25, v25, v166
    v_add_f32 v26, v26, v166
    v_add_f32 v27, v27, v166
    v_cvt_pk_bf16_f32 v20, 0, v20
    v_cvt_pk_bf16_f32 v21, 0, v21
    v_cvt_pk_bf16_f32 v22, 0, v22
    v_cvt_pk_bf16_f32 v23, 0, v23
    v_cvt_pk_bf16_f32 v24, 0, v24
    v_cvt_pk_bf16_f32 v25, 0, v25
    v_cvt_pk_bf16_f32 v26, 0, v26
    v_cvt_pk_bf16_f32 v27, 0, v27
    v_mul_f32 v20, v20, v167
    v_mul_f32 v21, v21, v167
    v_mul_f32 v22, v22, v167
    v_mul_f32 v23, v23, v167
    v_mul_f32 v24, v24, v167
    v_mul_f32 v25, v25, v167
    v_mul_f32 v26, v26, v167
    v_mul_f32 v27, v27, v167
    v_cvt_pk_bf16_f32 v76, v20, v21
    v_cvt_pk_bf16_f32 v77, v22, v23
    v_cvt_pk_bf16_f32 v78, v24, v25
    v_cvt_pk_bf16_f32 v79, v26, v27
    ds_write_b128 v14, v[76:79] offset:35840
    s_waitcnt vmcnt(6)
    v_mov_b32 v9, 4
    ds_write_b32 v7, v9
    s_wakeup
    v_lshlrev_b32 v20, 16, v80
    v_and_b32 v21, s61, v80
    v_lshlrev_b32 v22, 16, v81
    v_and_b32 v23, s61, v81
    v_lshlrev_b32 v24, 16, v82
    v_and_b32 v25, s61, v82
    v_lshlrev_b32 v26, 16, v83
    v_and_b32 v27, s61, v83
    v_add_f32 v20, v20, v160
    v_add_f32 v21, v21, v160
    v_add_f32 v22, v22, v160
    v_add_f32 v23, v23, v160
    v_add_f32 v24, v24, v160
    v_add_f32 v25, v25, v160
    v_add_f32 v26, v26, v160
    v_add_f32 v27, v27, v160
    v_cvt_pk_bf16_f32 v20, 0, v20
    v_cvt_pk_bf16_f32 v21, 0, v21
    v_cvt_pk_bf16_f32 v22, 0, v22
    v_cvt_pk_bf16_f32 v23, 0, v23
    v_cvt_pk_bf16_f32 v24, 0, v24
    v_cvt_pk_bf16_f32 v25, 0, v25
    v_cvt_pk_bf16_f32 v26, 0, v26
    v_cvt_pk_bf16_f32 v27, 0, v27
    v_mul_f32 v20, v20, v161
    v_mul_f32 v21, v21, v161
    v_mul_f32 v22, v22, v161
    v_mul_f32 v23, v23, v161
    v_mul_f32 v24, v24, v161
    v_mul_f32 v25, v25, v161
    v_mul_f32 v26, v26, v161
    v_mul_f32 v27, v27, v161
    v_cvt_pk_bf16_f32 v80, v20, v21
    v_cvt_pk_bf16_f32 v81, v22, v23
    v_cvt_pk_bf16_f32 v82, v24, v25
    v_cvt_pk_bf16_f32 v83, v26, v27
    v_lshlrev_b32 v20, 16, v84
    v_and_b32 v21, s61, v84
    v_lshlrev_b32 v22, 16, v85
    v_and_b32 v23, s61, v85
    v_lshlrev_b32 v24, 16, v86
    v_and_b32 v25, s61, v86
    v_lshlrev_b32 v26, 16, v87
    v_and_b32 v27, s61, v87
    v_add_f32 v20, v20, v162
    v_add_f32 v21, v21, v162
    v_add_f32 v22, v22, v162
    v_add_f32 v23, v23, v162
    v_add_f32 v24, v24, v162
    v_add_f32 v25, v25, v162
    v_add_f32 v26, v26, v162
    v_add_f32 v27, v27, v162
    v_cvt_pk_bf16_f32 v20, 0, v20
    v_cvt_pk_bf16_f32 v21, 0, v21
    v_cvt_pk_bf16_f32 v22, 0, v22
    v_cvt_pk_bf16_f32 v23, 0, v23
    v_cvt_pk_bf16_f32 v24, 0, v24
    v_cvt_pk_bf16_f32 v25, 0, v25
    v_cvt_pk_bf16_f32 v26, 0, v26
    v_cvt_pk_bf16_f32 v27, 0, v27
    v_mul_f32 v20, v20, v163
    v_mul_f32 v21, v21, v163
    v_mul_f32 v22, v22, v163
    v_mul_f32 v23, v23, v163
    v_mul_f32 v24, v24, v163
    v_mul_f32 v25, v25, v163
    v_mul_f32 v26, v26, v163
    v_mul_f32 v27, v27, v163
    v_cvt_pk_bf16_f32 v84, v20, v21
    v_cvt_pk_bf16_f32 v85, v22, v23
    v_cvt_pk_bf16_f32 v86, v24, v25
    v_cvt_pk_bf16_f32 v87, v26, v27
    s_mov_b32 s52, 0
M_VW1_L:
    ds_read_b32 v9, v8 offset:0
    s_add_u32 s52, s52, 1
    s_cmp_ge_u32 s52, 400000
    s_cbranch_scc1 M_VW1_X
    s_waitcnt lgkmcnt(0)
    v_cmp_gt_u32 vcc, 1, v9
    s_cbranch_vccz M_VW1_X
    s_sleep 4
    s_branch M_VW1_L
M_VW1_X:
    s_add_u32 s88, s87, 3
    s_and_b32 s88, s88, 7
    s_mul_i32 s88, s88, 176128
    s_add_u32 s88, s88, s56
    s_add_u32 m0, s55, 0
    s_nop 0
    buffer_load_dwordx4 v10, s[64:67], s88 offen lds
    s_add_u32 m0, s55, 1024
    s_nop 0
    buffer_load_dwordx4 v11, s[64:67], s88 offen lds
    s_add_u32 m0, s55, 2048
    s_nop 0
    buffer_load_dwordx4 v12, s[64:67], s88 offen lds
    s_waitcnt vmcnt(6)
    v_mov_b32 v9, 5
    ds_write_b32 v7, v9
    s_wakeup
    v_lshlrev_b32 v20, 16, v88
    v_and_b32 v21, s61, v88
    v_lshlrev_b32 v22, 16, v89
    v_and_b32 v23, s61, v89
    v_lshlrev_b32 v24, 16, v90
    v_and_b32 v25, s61, v90
    v_lshlrev_b32 v26, 16, v91
    v_and_b32 v27, s61, v91
    v_add_f32 v20, v20, v164
    v_add_f32 v21, v21, v164
    v_add_f32 v22, v22, v164
    v_add_f32 v23, v23, v164
    v_add_f32 v24, v24, v164
    v_add_f32 v25, v25, v164
    v_add_f32 v26, v26, v164
    v_add_f32 v27, v27, v164
    v_cvt_pk_bf16_f32 v20, 0, v20
    v_cvt_pk_bf16_f32 v21, 0, v21
    v_cvt_pk_bf16_f32 v22, 0, v22
    v_cvt_pk_bf16_f32 v23, 0, v23
    v_cvt_pk_bf16_f32 v24, 0, v24
    v_cvt_pk_bf16_f32 v25, 0, v25
    v_cvt_pk_bf16_f32 v26, 0, v26
    v_cvt_pk_bf16_f32 v27, 0, v27
    v_mul_f32 v20, v20, v165
    v_mul_f32 v21, v21, v165
    v_mul_f32 v22, v22, v165
    v_mul_f32 v23, v23, v165
    v_mul_f32 v24, v24, v165
    v_mul_f32 v25, v25, v165
    v_mul_f32 v26, v26, v165
    v_mul_f32 v27, v27, v165
    v_cvt_pk_bf16_f32 v88, v20, v21
    v_cvt_pk_bf16_f32 v89, v22, v23
    v_cvt_pk_bf16_f32 v90, v24, v25
    v_cvt_pk_bf16_f32 v91, v26, v27
    v_lshlrev_b32 v20, 16, v92
    v_and_b32 v21, s61, v92
    v_lshlrev_b32 v22, 16, v93
    v_and_b32 v23, s61, v93
    v_lshlrev_b32 v24, 16, v94
    v_and_b32 v25, s61, v94
    v_lshlrev_b32 v26, 16, v95
    v_and_b32 v27, s61, v95
    v_add_f32 v20, v20, v166
    v_add_f32 v21, v21, v166
    v_add_f32 v22, v22, v166
    v_add_f32 v23, v23, v166
    v_add_f32 v24, v24, v166
    v_add_f32 v25, v25, v166
    v_add_f32 v26, v26, v166
    v_add_f32 v27, v27, v166
    v_cvt_pk_bf16_f32 v20, 0, v20
    v_cvt_pk_bf16_f32 v21, 0, v21
    v_cvt_pk_bf16_f32 v22, 0, v22
    v_cvt_pk_bf16_f32 v23, 0, v23
    v_cvt_pk_bf16_f32 v24, 0, v24
    v_cvt_pk_bf16_f32 v25, 0, v25
    v_cvt_pk_bf16_f32 v26, 0, v26
    v_cvt_pk_bf16_f32 v27, 0, v27
    v_mul_f32 v20, v20, v167
    v_mul_f32 v21, v21, v167
    v_mul_f32 v22, v22, v167
    v_mul_f32 v23, v23, v167
    v_mul_f32 v24, v24, v167
    v_mul_f32 v25, v25, v167
    v_mul_f32 v26, v26, v167
    v_mul_f32 v27, v27, v167
    v_cvt_pk_bf16_f32 v92, v20, v21
    v_cvt_pk_bf16_f32 v93, v22, v23
    v_cvt_pk_bf16_f32 v94, v24, v25
    v_cvt_pk_bf16_f32 v95, v26, v27
    s_mov_b32 s52, 0
M_VW2_L:
    ds_read_b32 v9, v8 offset:0
    s_add_u32 s52, s52, 1
    s_cmp_ge_u32 s52, 400000
    s_cbranch_scc1 M_VW2_X
    s_waitcnt lgkmcnt(0)
    v_cmp_gt_u32 vcc, 2, v9
    s_cbranch_vccz M_VW2_X
    s_sleep 4
    s_branch M_VW2_L
M_VW2_X:
    ds_write_b128 v13, v[80:83] offset:0
    ds_write_b128 v14, v[84:87] offset:1024
    ds_write_b128 v13, v[88:91] offset:2048
    ds_write_b128 v14, v[92:95] offset:3072
    s_add_u32 s88, s87, 3
    s_and_b32 s88, s88, 7
    s_mul_i32 s88, s88, 176128
    s_add_u32 s88, s88, s56
    s_add_u32 s88, s88, 88064
    s_add_u32 m0, s55, 12288
    s_nop 0
    buffer_load_dwordx4 v10, s[64:67], s88 offen lds
    s_add_u32 m0, s55, 13312
    s_nop 0
    buffer_load_dwordx4 v11, s[64:67], s88 offen lds
    s_add_u32 m0, s55, 14336
    s_nop 0
    buffer_load_dwordx4 v12, s[64:67], s88 offen lds
    s_waitcnt vmcnt(6)
    v_mov_b32 v9, 6
    ds_write_b32 v7, v9
    s_wakeup
    s_mov_b32 s12, s44
    s_mov_b32 s13, s45
    s_mov_b32 s14, 0x158000
    s_mov_b32 s15, 0x00020000
    s_lshr_b32 s52, s2, 3
    s_mul_i32 s52, s52, 44032
    s_mul_i32 s53, s24, 11008
    s_add_u32 s52, s52, s53
    v_lshlrev_b32 v28, 7, v1
    buffer_load_dword v29, v28, s[12:15], s52 offen
    buffer_load_dword v30, v28, s[12:15], s52 offen offset:2816
    v_lshlrev_b32 v20, 16, v96
    v_and_b32 v21, s61, v96
    v_lshlrev_b32 v22, 16, v97
    v_and_b32 v23, s61, v97
    v_lshlrev_b32 v24, 16, v98
    v_and_b32 v25, s61, v98
    v_lshlrev_b32 v26, 16, v99
    v_and_b32 v27, s61, v99
    v_add_f32 v20, v20, v160
    v_add_f32 v21, v21, v160
    v_add_f32 v22, v22, v160
    v_add_f32 v23, v23, v160
    v_add_f32 v24, v24, v160
    v_add_f32 v25, v25, v160
    v_add_f32 v26, v26, v160
    v_add_f32 v27, v27, v160
    v_cvt_pk_bf16_f32 v20, 0, v20
    v_cvt_pk_bf16_f32 v21, 0, v21
    v_cvt_pk_bf16_f32 v22, 0, v22
    v_cvt_pk_bf16_f32 v23, 0, v23
    v_cvt_pk_bf16_f32 v24, 0, v24
    v_cvt_pk_bf16_f32 v25, 0, v25
    v_cvt_pk_bf16_f32 v26, 0, v26
    v_cvt_pk_bf16_f32 v27, 0, v27
    v_mul_f32 v20, v20, v161
    v_mul_f32 v21, v21, v161
    v_mul_f32 v22, v22, v161
    v_mul_f32 v23, v23, v161
    v_mul_f32 v24, v24, v161
    v_mul_f32 v25, v25, v161
    v_mul_f32 v26, v26, v161
    v_mul_f32 v27, v27, v161
    v_cvt_pk_bf16_f32 v96, v20, v21
    v_cvt_pk_bf16_f32 v97, v22, v23
    v_cvt_pk_bf16_f32 v98, v24, v25
    v_cvt_pk_bf16_f32 v99, v26, v27
    v_lshlrev_b32 v20, 16, v100
    v_and_b32 v21, s61, v100
    v_lshlrev_b32 v22, 16, v101
    v_and_b32 v23, s61, v101
    v_lshlrev_b32 v24, 16, v102
    v_and_b32 v25, s61, v102
    v_lshlrev_b32 v26, 16, v103
    v_and_b32 v27, s61, v103
    v_add_f32 v20, v20, v162
    v_add_f32 v21, v21, v162
    v_add_f32 v22, v22, v162
    v_add_f32 v23, v23, v162
    v_add_f32 v24, v24, v162
    v_add_f32 v25, v25, v162
    v_add_f32 v26, v26, v162
    v_add_f32 v27, v27, v162
    v_cvt_pk_bf16_f32 v20, 0, v20
    v_cvt_pk_bf16_f32 v21, 0, v21
    v_cvt_pk_bf16_f32 v22, 0, v22
    v_cvt_pk_bf16_f32 v23, 0, v23
    v_cvt_pk_bf16_f32 v24, 0, v24
    v_cvt_pk_bf16_f32 v25, 0, v25
    v_cvt_pk_bf16_f32 v26, 0, v26
    v_cvt_pk_bf16_f32 v27, 0, v27
    v_mul_f32 v20, v20, v163
    v_mul_f32 v21, v21, v163
    v_mul_f32 v22, v22, v163
    v_mul_f32 v23, v23, v163
    v_mul_f32 v24, v24, v163
    v_mul_f32 v25, v25, v163
    v_mul_f32 v26, v26, v163
    v_mul_f32 v27, v27, v163
    v_cvt_pk_bf16_f32 v100, v20, v21
    v_cvt_pk_bf16_f32 v101, v22, v23
    v_cvt_pk_bf16_f32 v102, v24, v25
    v_cvt_pk_bf16_f32 v103, v26, v27
    s_mov_b32 s52, 0
M_VW3_L:
    ds_read_b32 v9, v8 offset:0
    s_add_u32 s52, s52, 1
    s_cmp_ge_u32 s52, 400000
    s_cbranch_scc1 M_VW3_X
    s_waitcnt lgkmcnt(0)
    v_cmp_gt_u32 vcc, 3, v9
    s_cbranch_vccz M_VW3_X
    s_sleep 4
    s_branch M_VW3_L
M_VW3_X:
    s_add_u32 s88, s87, 4
    s_and_b32 s88, s88, 7
    s_mul_i32 s88, s88, 176128
    s_add_u32 s88, s88, s56
    s_add_u32 m0, s55, 24576
    s_nop 0
    buffer_load_dwordx4 v10, s[64:67], s88 offen lds
    s_add_u32 m0, s55, 25600
    s_nop 0
    buffer_load_dwordx4 v11, s[64:67], s88 offen lds
    s_add_u32 m0, s55, 26624
    s_nop 0
    buffer_load_dwordx4 v12, s[64:67], s88 offen lds
    s_waitcnt vmcnt(8)
    v_mov_b32 v9, 7
    ds_write_b32 v7, v9
    s_wakeup
    v_lshlrev_b32 v20, 16, v104
    v_and_b32 v21, s61, v104
    v_lshlrev_b32 v22, 16, v105
    v_and_b32 v23, s61, v105
    v_lshlrev_b32 v24, 16, v106
    v_and_b32 v25, s61, v106
    v_lshlrev_b32 v26, 16, v107
    v_and_b32 v27, s61, v107
    v_add_f32 v20, v20, v164
    v_add_f32 v21, v21, v164
    v_add_f32 v22, v22, v164
    v_add_f32 v23, v23, v164
    v_add_f32 v24, v24, v164
    v_add_f32 v25, v25, v164
    v_add_f32 v26, v26, v164
    v_add_f32 v27, v27, v164
    v_cvt_pk_bf16_f32 v20, 0, v20
    v_cvt_pk_bf16_f32 v21, 0, v21
    v_cvt_pk_bf16_f32 v22, 0, v22
    v_cvt_pk_bf16_f32 v23, 0, v23
    v_cvt_pk_bf16_f32 v24, 0, v24
    v_cvt_pk_bf16_f32 v25, 0, v25
    v_cvt_pk_bf16_f32 v26, 0, v26
    v_cvt_pk_bf16_f32 v27, 0, v27
    v_mul_f32 v20, v20, v165
    v_mul_f32 v21, v21, v165
    v_mul_f32 v22, v22, v165
    v_mul_f32 v23, v23, v165
    v_mul_f32 v24, v24, v165
    v_mul_f32 v25, v25, v165
    v_mul_f32 v26, v26, v165
    v_mul_f32 v27, v27, v165
    v_cvt_pk_bf16_f32 v104, v20, v21
    v_cvt_pk_bf16_f32 v105, v22, v23
    v_cvt_pk_bf16_f32 v106, v24, v25
    v_cvt_pk_bf16_f32 v107, v26, v27
    v_lshlrev_b32 v20, 16, v108
    v_and_b32 v21, s61, v108
    v_lshlrev_b32 v22, 16, v109
    v_and_b32 v23, s61, v109
    v_lshlrev_b32 v24, 16, v110
    v_and_b32 v25, s61, v110
    v_lshlrev_b32 v26, 16, v111
    v_and_b32 v27, s61, v111
    v_add_f32 v20, v20, v166
    v_add_f32 v21, v21, v166
    v_add_f32 v22, v22, v166
    v_add_f32 v23, v23, v166
    v_add_f32 v24, v24, v166
    v_add_f32 v25, v25, v166
    v_add_f32 v26, v26, v166
    v_add_f32 v27, v27, v166
    v_cvt_pk_bf16_f32 v20, 0, v20
    v_cvt_pk_bf16_f32 v21, 0, v21
    v_cvt_pk_bf16_f32 v22, 0, v22
    v_cvt_pk_bf16_f32 v23, 0, v23
    v_cvt_pk_bf16_f32 v24, 0, v24
    v_cvt_pk_bf16_f32 v25, 0, v25
    v_cvt_pk_bf16_f32 v26, 0, v26
    v_cvt_pk_bf16_f32 v27, 0, v27
    v_mul_f32 v20, v20, v167
    v_mul_f32 v21, v21, v167
    v_mul_f32 v22, v22, v167
    v_mul_f32 v23, v23, v167
    v_mul_f32 v24, v24, v167
    v_mul_f32 v25, v25, v167
    v_mul_f32 v26, v26, v167
    v_mul_f32 v27, v27, v167
    v_cvt_pk_bf16_f32 v108, v20, v21
    v_cvt_pk_bf16_f32 v109, v22, v23
    v_cvt_pk_bf16_f32 v110, v24, v25
    v_cvt_pk_bf16_f32 v111, v26, v27
    s_mov_b32 s52, 0
M_VW4_L:
    ds_read_b32 v9, v8 offset:0
    s_add_u32 s52, s52, 1
    s_cmp_ge_u32 s52, 400000
    s_cbranch_scc1 M_VW4_X
    s_waitcnt lgkmcnt(0)
    v_cmp_gt_u32 vcc, 4, v9
    s_cbranch_vccz M_VW4_X
    s_sleep 4
    s_branch M_VW4_L
M_VW4_X:
    ds_write_b128 v13, v[96:99] offset:16384
    ds_write_b128 v14, v[100:103] offset:17408
    ds_write_b128 v13, v[104:107] offset:18432
    ds_write_b128 v14, v[108:111] offset:19456
    s_add_u32 s88, s87, 4
    s_and_b32 s88, s88, 7
    s_mul_i32 s88, s88, 176128
    s_add_u32 s88, s88, s56
    s_add_u32 s88, s88, 88064
    s_add_u32 m0, s55, 36864
    s_nop 0
    buffer_load_dwordx4 v10, s[64:67], s88 offen lds
    s_add_u32 m0, s55, 37888
    s_nop 0
    buffer_load_dwordx4 v11, s[64:67], s88 offen lds
    s_add_u32 m0, s55, 38912
    s_nop 0
    buffer_load_dwordx4 v12, s[64:67], s88 offen lds
    s_waitcnt vmcnt(8)
    v_mov_b32 v9, 8
    ds_write_b32 v7, v9
    s_wakeup
    v_lshlrev_b32 v20, 16, v112
    v_and_b32 v21, s61, v112
    v_lshlrev_b32 v22, 16, v113
    v_and_b32 v23, s61, v113
    v_lshlrev_b32 v24, 16, v114
    v_and_b32 v25, s61, v114
    v_lshlrev_b32 v26, 16, v115
    v_and_b32 v27, s61, v115
    v_add_f32 v20, v20, v160
    v_add_f32 v21, v21, v160
    v_add_f32 v22, v22, v160
    v_add_f32 v23, v23, v160
    v_add_f32 v24, v24, v160
    v_add_f32 v25, v25, v160
    v_add_f32 v26, v26, v160
    v_add_f32 v27, v27, v160
    v_cvt_pk_bf16_f32 v20, 0, v20
    v_cvt_pk_bf16_f32 v21, 0, v21
    v_cvt_pk_bf16_f32 v22, 0, v22
    v_cvt_pk_bf16_f32 v23, 0, v23
    v_cvt_pk_bf16_f32 v24, 0, v24
    v_cvt_pk_bf16_f32 v25, 0, v25
    v_cvt_pk_bf16_f32 v26, 0, v26
    v_cvt_pk_bf16_f32 v27, 0, v27
    v_mul_f32 v20, v20, v161
    v_mul_f32 v21, v21, v161
    v_mul_f32 v22, v22, v161
    v_mul_f32 v23, v23, v161
    v_mul_f32 v24, v24, v161
    v_mul_f32 v25, v25, v161
    v_mul_f32 v26, v26, v161
    v_mul_f32 v27, v27, v161
    v_cvt_pk_bf16_f32 v112, v20, v21
    v_cvt_pk_bf16_f32 v113, v22, v23
    v_cvt_pk_bf16_f32 v114, v24, v25
    v_cvt_pk_bf16_f32 v115, v26, v27
    v_lshlrev_b32 v20, 16, v116
    v_and_b32 v21, s61, v116
    v_lshlrev_b32 v22, 16, v117
    v_and_b32 v23, s61, v117
    v_lshlrev_b32 v24, 16, v118
    v_and_b32 v25, s61, v118
    v_lshlrev_b32 v26, 16, v119
    v_and_b32 v27, s61, v119
    v_add_f32 v20, v20, v162
    v_add_f32 v21, v21, v162
    v_add_f32 v22, v22, v162
    v_add_f32 v23, v23, v162
    v_add_f32 v24, v24, v162
    v_add_f32 v25, v25, v162
    v_add_f32 v26, v26, v162
    v_add_f32 v27, v27, v162
    v_cvt_pk_bf16_f32 v20, 0, v20
    v_cvt_pk_bf16_f32 v21, 0, v21
    v_cvt_pk_bf16_f32 v22, 0, v22
    v_cvt_pk_bf16_f32 v23, 0, v23
    v_cvt_pk_bf16_f32 v24, 0, v24
    v_cvt_pk_bf16_f32 v25, 0, v25
    v_cvt_pk_bf16_f32 v26, 0, v26
    v_cvt_pk_bf16_f32 v27, 0, v27
    v_mul_f32 v20, v20, v163
    v_mul_f32 v21, v21, v163
    v_mul_f32 v22, v22, v163
    v_mul_f32 v23, v23, v163
    v_mul_f32 v24, v24, v163
    v_mul_f32 v25, v25, v163
    v_mul_f32 v26, v26, v163
    v_mul_f32 v27, v27, v163
    v_cvt_pk_bf16_f32 v116, v20, v21
    v_cvt_pk_bf16_f32 v117, v22, v23
    v_cvt_pk_bf16_f32 v118, v24, v25
    v_cvt_pk_bf16_f32 v119, v26, v27
    s_mov_b32 s52, 0
M_VW5_L:
    ds_read_b32 v9, v8 offset:0
    s_add_u32 s52, s52, 1
    s_cmp_ge_u32 s52, 400000
    s_cbranch_scc1 M_VW5_X
    s_waitcnt lgkmcnt(0)
    v_cmp_gt_u32 vcc, 5, v9
    s_cbranch_vccz M_VW5_X
    s_sleep 4
    s_branch M_VW5_L
M_VW5_X:
    s_add_u32 s88, s87, 5
    s_and_b32 s88, s88, 7
    s_mul_i32 s88, s88, 176128
    s_add_u32 s88, s88, s56
    s_add_u32 m0, s55, 49152
    s_nop 0
    buffer_load_dwordx4 v10, s[64:67], s88 offen lds
    s_add_u32 m0, s55, 50176
    s_nop 0
    buffer_load_dwordx4 v11, s[64:67], s88 offen lds
    s_add_u32 m0, s55, 51200
    s_nop 0
    buffer_load_dwordx4 v12, s[64:67], s88 offen lds
    s_waitcnt vmcnt(6)
    v_mov_b32 v9, 9
    ds_write_b32 v7, v9
    s_wakeup
    v_lshlrev_b32 v20, 16, v120
    v_and_b32 v21, s61, v120
    v_lshlrev_b32 v22, 16, v121
    v_and_b32 v23, s61, v121
    v_lshlrev_b32 v24, 16, v122
    v_and_b32 v25, s61, v122
    v_lshlrev_b32 v26, 16, v123
    v_and_b32 v27, s61, v123
    v_add_f32 v20, v20, v164
    v_add_f32 v21, v21, v164
    v_add_f32 v22, v22, v164
    v_add_f32 v23, v23, v164
    v_add_f32 v24, v24, v164
    v_add_f32 v25, v25, v164
    v_add_f32 v26, v26, v164
    v_add_f32 v27, v27, v164
    v_cvt_pk_bf16_f32 v20, 0, v20
    v_cvt_pk_bf16_f32 v21, 0, v21
    v_cvt_pk_bf16_f32 v22, 0, v22
    v_cvt_pk_bf16_f32 v23, 0, v23
    v_cvt_pk_bf16_f32 v24, 0, v24
    v_cvt_pk_bf16_f32 v25, 0, v25
    v_cvt_pk_bf16_f32 v26, 0, v26
    v_cvt_pk_bf16_f32 v27, 0, v27
    v_mul_f32 v20, v20, v165
    v_mul_f32 v21, v21, v165
    v_mul_f32 v22, v22, v165
    v_mul_f32 v23, v23, v165
    v_mul_f32 v24, v24, v165
    v_mul_f32 v25, v25, v165
    v_mul_f32 v26, v26, v165
    v_mul_f32 v27, v27, v165
    v_cvt_pk_bf16_f32 v120, v20, v21
    v_cvt_pk_bf16_f32 v121, v22, v23
    v_cvt_pk_bf16_f32 v122, v24, v25
    v_cvt_pk_bf16_f32 v123, v26, v27
    v_lshlrev_b32 v20, 16, v124
    v_and_b32 v21, s61, v124
    v_lshlrev_b32 v22, 16, v125
    v_and_b32 v23, s61, v125
    v_lshlrev_b32 v24, 16, v126
    v_and_b32 v25, s61, v126
    v_lshlrev_b32 v26, 16, v127
    v_and_b32 v27, s61, v127
    v_add_f32 v20, v20, v166
    v_add_f32 v21, v21, v166
    v_add_f32 v22, v22, v166
    v_add_f32 v23, v23, v166
    v_add_f32 v24, v24, v166
    v_add_f32 v25, v25, v166
    v_add_f32 v26, v26, v166
    v_add_f32 v27, v27, v166
    v_cvt_pk_bf16_f32 v20, 0, v20
    v_cvt_pk_bf16_f32 v21, 0, v21
    v_cvt_pk_bf16_f32 v22, 0, v22
    v_cvt_pk_bf16_f32 v23, 0, v23
    v_cvt_pk_bf16_f32 v24, 0, v24
    v_cvt_pk_bf16_f32 v25, 0, v25
    v_cvt_pk_bf16_f32 v26, 0, v26
    v_cvt_pk_bf16_f32 v27, 0, v27
    v_mul_f32 v20, v20, v167
    v_mul_f32 v21, v21, v167
    v_mul_f32 v22, v22, v167
    v_mul_f32 v23, v23, v167
    v_mul_f32 v24, v24, v167
    v_mul_f32 v25, v25, v167
    v_mul_f32 v26, v26, v167
    v_mul_f32 v27, v27, v167
    v_cvt_pk_bf16_f32 v124, v20, v21
    v_cvt_pk_bf16_f32 v125, v22, v23
    v_cvt_pk_bf16_f32 v126, v24, v25
    v_cvt_pk_bf16_f32 v127, v26, v27
    s_mov_b32 s52, 0
M_VW6_L:
    ds_read_b32 v9, v8 offset:0
    s_add_u32 s52, s52, 1
    s_cmp_ge_u32 s52, 400000
    s_cbranch_scc1 M_VW6_X
    s_waitcnt lgkmcnt(0)
    v_cmp_gt_u32 vcc, 6, v9
    s_cbranch_vccz M_VW6_X
    s_sleep 4
    s_branch M_VW6_L
M_VW6_X:
    ds_write_b128 v13, v[112:115] offset:32768
    ds_write_b128 v14, v[116:119] offset:33792
    ds_write_b128 v13, v[120:123] offset:34816
    ds_write_b128 v14, v[124:127] offset:35840
    s_add_u32 s88, s87, 5
    s_and_b32 s88, s88, 7
    s_mul_i32 s88, s88, 176128
    s_add_u32 s88, s88, s56
    s_add_u32 s88, s88, 88064
    s_add_u32 m0, s55, 61440
    s_nop 0
    buffer_load_dwordx4 v10, s[64:67], s88 offen lds
    s_add_u32 m0, s55, 62464
    s_nop 0
    buffer_load_dwordx4 v11, s[64:67], s88 offen lds
    s_add_u32 m0, s55, 63488
    s_nop 0
    buffer_load_dwordx4 v12, s[64:67], s88 offen lds
    s_waitcnt vmcnt(6)
    v_mov_b32 v9, 10
    ds_write_b32 v7, v9
    s_wakeup
    v_lshlrev_b32 v20, 16, v128
    v_and_b32 v21, s61, v128
    v_lshlrev_b32 v22, 16, v129
    v_and_b32 v23, s61, v129
    v_lshlrev_b32 v24, 16, v130
    v_and_b32 v25, s61, v130
    v_lshlrev_b32 v26, 16, v131
    v_and_b32 v27, s61, v131
    v_add_f32 v20, v20, v160
    v_add_f32 v21, v21, v160
    v_add_f32 v22, v22, v160
    v_add_f32 v23, v23, v160
    v_add_f32 v24, v24, v160
    v_add_f32 v25, v25, v160
    v_add_f32 v26, v26, v160
    v_add_f32 v27, v27, v160
    v_cvt_pk_bf16_f32 v20, 0, v20
    v_cvt_pk_bf16_f32 v21, 0, v21
    v_cvt_pk_bf16_f32 v22, 0, v22
    v_cvt_pk_bf16_f32 v23, 0, v23
    v_cvt_pk_bf16_f32 v24, 0, v24
    v_cvt_pk_bf16_f32 v25, 0, v25
    v_cvt_pk_bf16_f32 v26, 0, v26
    v_cvt_pk_bf16_f32 v27, 0, v27
    v_mul_f32 v20, v20, v161
    v_mul_f32 v21, v21, v161
    v_mul_f32 v22, v22, v161
    v_mul_f32 v23, v23, v161
    v_mul_f32 v24, v24, v161
    v_mul_f32 v25, v25, v161
    v_mul_f32 v26, v26, v161
    v_mul_f32 v27, v27, v161
    v_cvt_pk_bf16_f32 v128, v20, v21
    v_cvt_pk_bf16_f32 v129, v22, v23
    v_cvt_pk_bf16_f32 v130, v24, v25
    v_cvt_pk_bf16_f32 v131, v26, v27
    v_lshlrev_b32 v20, 16, v132
    v_and_b32 v21, s61, v132
    v_lshlrev_b32 v22, 16, v133
    v_and_b32 v23, s61, v133
    v_lshlrev_b32 v24, 16, v134
    v_and_b32 v25, s61, v134
    v_lshlrev_b32 v26, 16, v135
    v_and_b32 v27, s61, v135
    v_add_f32 v20, v20, v162
    v_add_f32 v21, v21, v162
    v_add_f32 v22, v22, v162
    v_add_f32 v23, v23, v162
    v_add_f32 v24, v24, v162
    v_add_f32 v25, v25, v162
    v_add_f32 v26, v26, v162
    v_add_f32 v27, v27, v162
    v_cvt_pk_bf16_f32 v20, 0, v20
    v_cvt_pk_bf16_f32 v21, 0, v21
    v_cvt_pk_bf16_f32 v22, 0, v22
    v_cvt_pk_bf16_f32 v23, 0, v23
    v_cvt_pk_bf16_f32 v24, 0, v24
    v_cvt_pk_bf16_f32 v25, 0, v25
    v_cvt_pk_bf16_f32 v26, 0, v26
    v_cvt_pk_bf16_f32 v27, 0, v27
    v_mul_f32 v20, v20, v163
    v_mul_f32 v21, v21, v163
    v_mul_f32 v22, v22, v163
    v_mul_f32 v23, v23, v163
    v_mul_f32 v24, v24, v163
    v_mul_f32 v25, v25, v163
    v_mul_f32 v26, v26, v163
    v_mul_f32 v27, v27, v163
    v_cvt_pk_bf16_f32 v132, v20, v21
    v_cvt_pk_bf16_f32 v133, v22, v23
    v_cvt_pk_bf16_f32 v134, v24, v25
    v_cvt_pk_bf16_f32 v135, v26, v27
    s_mov_b32 s52, 0
M_VW7_L:
    ds_read_b32 v9, v8 offset:0
    s_add_u32 s52, s52, 1
    s_cmp_ge_u32 s52, 400000
    s_cbranch_scc1 M_VW7_X
    s_waitcnt lgkmcnt(0)
    v_cmp_gt_u32 vcc, 7, v9
    s_cbranch_vccz M_VW7_X
    s_sleep 4
    s_branch M_VW7_L
M_VW7_X:
    s_add_u32 s88, s87, 6
    s_and_b32 s88, s88, 7
    s_mul_i32 s88, s88, 176128
    s_add_u32 s88, s88, s56
    s_add_u32 m0, s55, 0
    s_nop 0
    buffer_load_dwordx4 v10, s[64:67], s88 offen lds
    s_add_u32 m0, s55, 1024
    s_nop 0
    buffer_load_dwordx4 v11, s[64:67], s88 offen lds
    s_add_u32 m0, s55, 2048
    s_nop 0
    buffer_load_dwordx4 v12, s[64:67], s88 offen lds
    s_waitcnt vmcnt(6)
    v_mov_b32 v9, 11
    ds_write_b32 v7, v9
    s_wakeup
    v_lshlrev_b32 v20, 16, v136
    v_and_b32 v21, s61, v136
    v_lshlrev_b32 v22, 16, v137
    v_and_b32 v23, s61, v137
    v_lshlrev_b32 v24, 16, v138
    v_and_b32 v25, s61, v138
    v_lshlrev_b32 v26, 16, v139
    v_and_b32 v27, s61, v139
    v_add_f32 v20, v20, v164
    v_add_f32 v21, v21, v164
    v_add_f32 v22, v22, v164
    v_add_f32 v23, v23, v164
    v_add_f32 v24, v24, v164
    v_add_f32 v25, v25, v164
    v_add_f32 v26, v26, v164
    v_add_f32 v27, v27, v164
    v_cvt_pk_bf16_f32 v20, 0, v20
    v_cvt_pk_bf16_f32 v21, 0, v21
    v_cvt_pk_bf16_f32 v22, 0, v22
    v_cvt_pk_bf16_f32 v23, 0, v23
    v_cvt_pk_bf16_f32 v24, 0, v24
    v_cvt_pk_bf16_f32 v25, 0, v25
    v_cvt_pk_bf16_f32 v26, 0, v26
    v_cvt_pk_bf16_f32 v27, 0, v27
    v_mul_f32 v20, v20, v165
    v_mul_f32 v21, v21, v165
    v_mul_f32 v22, v22, v165
    v_mul_f32 v23, v23, v165
    v_mul_f32 v24, v24, v165
    v_mul_f32 v25, v25, v165
    v_mul_f32 v26, v26, v165
    v_mul_f32 v27, v27, v165
    v_cvt_pk_bf16_f32 v136, v20, v21
    v_cvt_pk_bf16_f32 v137, v22, v23
    v_cvt_pk_bf16_f32 v138, v24, v25
    v_cvt_pk_bf16_f32 v139, v26, v27
    v_lshlrev_b32 v20, 16, v140
    v_and_b32 v21, s61, v140
    v_lshlrev_b32 v22, 16, v141
    v_and_b32 v23, s61, v141
    v_lshlrev_b32 v24, 16, v142
    v_and_b32 v25, s61, v142
    v_lshlrev_b32 v26, 16, v143
    v_and_b32 v27, s61, v143
    v_add_f32 v20, v20, v166
    v_add_f32 v21, v21, v166
    v_add_f32 v22, v22, v166
    v_add_f32 v23, v23, v166
    v_add_f32 v24, v24, v166
    v_add_f32 v25, v25, v166
    v_add_f32 v26, v26, v166
    v_add_f32 v27, v27, v166
    v_cvt_pk_bf16_f32 v20, 0, v20
    v_cvt_pk_bf16_f32 v21, 0, v21
    v_cvt_pk_bf16_f32 v22, 0, v22
    v_cvt_pk_bf16_f32 v23, 0, v23
    v_cvt_pk_bf16_f32 v24, 0, v24
    v_cvt_pk_bf16_f32 v25, 0, v25
    v_cvt_pk_bf16_f32 v26, 0, v26
    v_cvt_pk_bf16_f32 v27, 0, v27
    v_mul_f32 v20, v20, v167
    v_mul_f32 v21, v21, v167
    v_mul_f32 v22, v22, v167
    v_mul_f32 v23, v23, v167
    v_mul_f32 v24, v24, v167
    v_mul_f32 v25, v25, v167
    v_mul_f32 v26, v26, v167
    v_mul_f32 v27, v27, v167
    v_cvt_pk_bf16_f32 v140, v20, v21
    v_cvt_pk_bf16_f32 v141, v22, v23
    v_cvt_pk_bf16_f32 v142, v24, v25
    v_cvt_pk_bf16_f32 v143, v26, v27
    s_mov_b32 s52, 0
M_VW8_L:
    ds_read_b32 v9, v8 offset:0
    s_add_u32 s52, s52, 1
    s_cmp_ge_u32 s52, 400000
    s_cbranch_scc1 M_VW8_X
    s_waitcnt lgkmcnt(0)
    v_cmp_gt_u32 vcc, 8, v9
    s_cbranch_vccz M_VW8_X
    s_sleep 4
    s_branch M_VW8_L
M_VW8_X:
    ds_write_b128 v13, v[128:131] offset:0
    ds_write_b128 v14, v[132:135] offset:1024
    ds_write_b128 v13, v[136:139] offset:2048
    ds_write_b128 v14, v[140:143] offset:3072
    s_add_u32 s88, s87, 6
    s_and_b32 s88, s88, 7
    s_mul_i32 s88, s88, 176128
    s_add_u32 s88, s88, s56
    s_add_u32 s88, s88, 88064
    s_add_u32 m0, s55, 12288
    s_nop 0
    buffer_load_dwordx4 v10, s[64:67], s88 offen lds
    s_add_u32 m0, s55, 13312
    s_nop 0
    buffer_load_dwordx4 v11, s[64:67], s88 offen lds
    s_add_u32 m0, s55, 14336
    s_nop 0
    buffer_load_dwordx4 v12, s[64:67], s88 offen lds
    s_waitcnt vmcnt(6)
    v_mov_b32 v9, 12
    ds_write_b32 v7, v9
    s_wakeup
    v_lshlrev_b32 v20, 16, v144
    v_and_b32 v21, s61, v144
    v_lshlrev_b32 v22, 16, v145
    v_and_b32 v23, s61, v145
    v_lshlrev_b32 v24, 16, v146
    v_and_b32 v25, s61, v146
    v_lshlrev_b32 v26, 16, v147
    v_and_b32 v27, s61, v147
    v_add_f32 v20, v20, v160
    v_add_f32 v21, v21, v160
    v_add_f32 v22, v22, v160
    v_add_f32 v23, v23, v160
    v_add_f32 v24, v24, v160
    v_add_f32 v25, v25, v160
    v_add_f32 v26, v26, v160
    v_add_f32 v27, v27, v160
    v_cvt_pk_bf16_f32 v20, 0, v20
    v_cvt_pk_bf16_f32 v21, 0, v21
    v_cvt_pk_bf16_f32 v22, 0, v22
    v_cvt_pk_bf16_f32 v23, 0, v23
    v_cvt_pk_bf16_f32 v24, 0, v24
    v_cvt_pk_bf16_f32 v25, 0, v25
    v_cvt_pk_bf16_f32 v26, 0, v26
    v_cvt_pk_bf16_f32 v27, 0, v27
    v_mul_f32 v20, v20, v161
    v_mul_f32 v21, v21, v161
    v_mul_f32 v22, v22, v161
    v_mul_f32 v23, v23, v161
    v_mul_f32 v24, v24, v161
    v_mul_f32 v25, v25, v161
    v_mul_f32 v26, v26, v161
    v_mul_f32 v27, v27, v161
    v_cvt_pk_bf16_f32 v144, v20, v21
    v_cvt_pk_bf16_f32 v145, v22, v23
    v_cvt_pk_bf16_f32 v146, v24, v25
    v_cvt_pk_bf16_f32 v147, v26, v27
    v_lshlrev_b32 v20, 16, v148
    v_and_b32 v21, s61, v148
    v_lshlrev_b32 v22, 16, v149
    v_and_b32 v23, s61, v149
    v_lshlrev_b32 v24, 16, v150
    v_and_b32 v25, s61, v150
    v_lshlrev_b32 v26, 16, v151
    v_and_b32 v27, s61, v151
    v_add_f32 v20, v20, v162
    v_add_f32 v21, v21, v162
    v_add_f32 v22, v22, v162
    v_add_f32 v23, v23, v162
    v_add_f32 v24, v24, v162
    v_add_f32 v25, v25, v162
    v_add_f32 v26, v26, v162
    v_add_f32 v27, v27, v162
    v_cvt_pk_bf16_f32 v20, 0, v20
    v_cvt_pk_bf16_f32 v21, 0, v21
    v_cvt_pk_bf16_f32 v22, 0, v22
    v_cvt_pk_bf16_f32 v23, 0, v23
    v_cvt_pk_bf16_f32 v24, 0, v24
    v_cvt_pk_bf16_f32 v25, 0, v25
    v_cvt_pk_bf16_f32 v26, 0, v26
    v_cvt_pk_bf16_f32 v27, 0, v27
    v_mul_f32 v20, v20, v163
    v_mul_f32 v21, v21, v163
    v_mul_f32 v22, v22, v163
    v_mul_f32 v23, v23, v163
    v_mul_f32 v24, v24, v163
    v_mul_f32 v25, v25, v163
    v_mul_f32 v26, v26, v163
    v_mul_f32 v27, v27, v163
    v_cvt_pk_bf16_f32 v148, v20, v21
    v_cvt_pk_bf16_f32 v149, v22, v23
    v_cvt_pk_bf16_f32 v150, v24, v25
    v_cvt_pk_bf16_f32 v151, v26, v27
    s_mov_b32 s52, 0
M_VW9_L:
    ds_read_b32 v9, v8 offset:0
    s_add_u32 s52, s52, 1
    s_cmp_ge_u32 s52, 400000
    s_cbranch_scc1 M_VW9_X
    s_waitcnt lgkmcnt(0)
    v_cmp_gt_u32 vcc, 9, v9
    s_cbranch_vccz M_VW9_X
    s_sleep 4
    s_branch M_VW9_L
M_VW9_X:
    s_add_u32 s88, s87, 7
    s_and_b32 s88, s88, 7
    s_mul_i32 s88, s88, 176128
    s_add_u32 s88, s88, s56
    s_add_u32 m0, s55, 24576
    s_nop 0
    buffer_load_dwordx4 v10, s[64:67], s88 offen lds
    s_add_u32 m0, s55, 25600
    s_nop 0
    buffer_load_dwordx4 v11, s[64:67], s88 offen lds
    s_add_u32 m0, s55, 26624
    s_nop 0
    buffer_load_dwordx4 v12, s[64:67], s88 offen lds
    s_waitcnt vmcnt(6)
    v_mov_b32 v9, 13
    ds_write_b32 v7, v9
    s_wakeup
    v_lshlrev_b32 v20, 16, v152
    v_and_b32 v21, s61, v152
    v_lshlrev_b32 v22, 16, v153
    v_and_b32 v23, s61, v153
    v_lshlrev_b32 v24, 16, v154
    v_and_b32 v25, s61, v154
    v_lshlrev_b32 v26, 16, v155
    v_and_b32 v27, s61, v155
    v_add_f32 v20, v20, v164
    v_add_f32 v21, v21, v164
    v_add_f32 v22, v22, v164
    v_add_f32 v23, v23, v164
    v_add_f32 v24, v24, v164
    v_add_f32 v25, v25, v164
    v_add_f32 v26, v26, v164
    v_add_f32 v27, v27, v164
    v_cvt_pk_bf16_f32 v20, 0, v20
    v_cvt_pk_bf16_f32 v21, 0, v21
    v_cvt_pk_bf16_f32 v22, 0, v22
    v_cvt_pk_bf16_f32 v23, 0, v23
    v_cvt_pk_bf16_f32 v24, 0, v24
    v_cvt_pk_bf16_f32 v25, 0, v25
    v_cvt_pk_bf16_f32 v26, 0, v26
    v_cvt_pk_bf16_f32 v27, 0, v27
    v_mul_f32 v20, v20, v165
    v_mul_f32 v21, v21, v165
    v_mul_f32 v22, v22, v165
    v_mul_f32 v23, v23, v165
    v_mul_f32 v24, v24, v165
    v_mul_f32 v25, v25, v165
    v_mul_f32 v26, v26, v165
    v_mul_f32 v27, v27, v165
    v_cvt_pk_bf16_f32 v152, v20, v21
    v_cvt_pk_bf16_f32 v153, v22, v23
    v_cvt_pk_bf16_f32 v154, v24, v25
    v_cvt_pk_bf16_f32 v155, v26, v27
    v_lshlrev_b32 v20, 16, v156
    v_and_b32 v21, s61, v156
    v_lshlrev_b32 v22, 16, v157
    v_and_b32 v23, s61, v157
    v_lshlrev_b32 v24, 16, v158
    v_and_b32 v25, s61, v158
    v_lshlrev_b32 v26, 16, v159
    v_and_b32 v27, s61, v159
    v_add_f32 v20, v20, v166
    v_add_f32 v21, v21, v166
    v_add_f32 v22, v22, v166
    v_add_f32 v23, v23, v166
    v_add_f32 v24, v24, v166
    v_add_f32 v25, v25, v166
    v_add_f32 v26, v26, v166
    v_add_f32 v27, v27, v166
    v_cvt_pk_bf16_f32 v20, 0, v20
    v_cvt_pk_bf16_f32 v21, 0, v21
    v_cvt_pk_bf16_f32 v22, 0, v22
    v_cvt_pk_bf16_f32 v23, 0, v23
    v_cvt_pk_bf16_f32 v24, 0, v24
    v_cvt_pk_bf16_f32 v25, 0, v25
    v_cvt_pk_bf16_f32 v26, 0, v26
    v_cvt_pk_bf16_f32 v27, 0, v27
    v_mul_f32 v20, v20, v167
    v_mul_f32 v21, v21, v167
    v_mul_f32 v22, v22, v167
    v_mul_f32 v23, v23, v167
    v_mul_f32 v24, v24, v167
    v_mul_f32 v25, v25, v167
    v_mul_f32 v26, v26, v167
    v_mul_f32 v27, v27, v167
    v_cvt_pk_bf16_f32 v156, v20, v21
    v_cvt_pk_bf16_f32 v157, v22, v23
    v_cvt_pk_bf16_f32 v158, v24, v25
    v_cvt_pk_bf16_f32 v159, v26, v27
    s_mov_b32 s52, 0
M_VW10_L:
    ds_read_b32 v9, v8 offset:0
    s_add_u32 s52, s52, 1
    s_cmp_ge_u32 s52, 400000
    s_cbranch_scc1 M_VW10_X
    s_waitcnt lgkmcnt(0)
    v_cmp_gt_u32 vcc, 10, v9
    s_cbranch_vccz M_VW10_X
    s_sleep 4
    s_branch M_VW10_L
M_VW10_X:
    ds_write_b128 v13, v[144:147] offset:16384
    ds_write_b128 v14, v[148:151] offset:17408
    ds_write_b128 v13, v[152:155] offset:18432
    ds_write_b128 v14, v[156:159] offset:19456
    s_add_u32 s88, s87, 7
    s_and_b32 s88, s88, 7
    s_mul_i32 s88, s88, 176128
    s_add_u32 s88, s88, s56
    s_add_u32 s88, s88, 88064
    s_add_u32 m0, s55, 36864
    s_nop 0
    buffer_load_dwordx4 v10, s[64:67], s88 offen lds
    s_add_u32 m0, s55, 37888
    s_nop 0
    buffer_load_dwordx4 v11, s[64:67], s88 offen lds
    s_add_u32 m0, s55, 38912
    s_nop 0
    buffer_load_dwordx4 v12, s[64:67], s88 offen lds
    s_waitcnt vmcnt(6)
    v_mov_b32 v9, 14
    ds_write_b32 v7, v9
    s_wakeup
    s_waitcnt vmcnt(3)
    v_mov_b32 v9, 15
    ds_write_b32 v7, v9
    s_wakeup
    s_waitcnt vmcnt(0)
    v_mov_b32 v9, 16
    ds_write_b32 v7, v9
    s_wakeup
M_V2:
    s_mov_b32 s4, s50
    s_mov_b32 s5, s51
    s_mov_b32 s6, 0x1c00000
    s_mov_b32 s7, 0x00020000
    s_mov_b32 s63, 0
    s_and_b32 s54, s2, 7
    s_lshl_b32 s54, s54, 2
    s_bfe_u32 s52, s2, 0x20003
    s_add_u32 s54, s54, s52
    s_bfe_u32 s55, s2, 0x30005
    s_lshl_b32 s62, s24, 11
    s_add_u32 s62, s62, 57344
    s_mul_i32 s57, s24, 360448
    s_lshl_b32 s52, s55, 7
    s_add_u32 s57, s57, s52
    v_lshrrev_b32 v16, 3, v1
    v_lshlrev_b32 v4, 10, v16
    v_bfe_u32 v17, v1, 4, 1
    v_lshlrev_b32 v17, 2, v17
    v_xor_b32 v17, v17, v1
    v_and_b32 v17, 7, v17
    v_lshl_add_u32 v4, v17, 4, v4
    s_mov_b32 s12, s44
    s_mov_b32 s13, s45
    s_mov_b32 s14, 0x158000
    s_mov_b32 s15, 0x00020000
    v_lshrrev_b32 v16, 5, v1
    v_bfe_u32 v17, v1, 2, 2
    v_lshl_add_u32 v16, v16, 3, v17
    v_lshlrev_b32 v16, 7, v16
    v_and_b32 v17, 1, v1
    v_lshl_add_u32 v16, v17, 5, v16
    v_bfe_u32 v17, v1, 4, 1
    v_lshl_add_u32 v16, v17, 4, v16
    v_bfe_u32 v17, v1, 1, 1
    v_lshl_add_u32 v16, v17, 3, v16
    v_bfe_u32 v17, v1, 3, 1
    v_lshl_add_u32 v16, v17, 6, v16
    v_add_u32 v5, s62, v16
    v_xor_b32 v10, 64, v5
    v_add_u32 v14, 57344, v5
    v_add_u32 v15, 57344, v10
    s_mul_i32 s52, s24, 260
    s_add_u32 s53, s52, 36032
    v_mov_b32 v11, s53
    s_add_u32 s53, s52, 35008
    v_mov_b32 v12, s53
    v_mov_b32 v13, 34880
    s_mov_b32 s52, 0
M_GN0_L:
    ds_read_b32 v9, v13 offset:0
    s_add_u32 s52, s52, 1
    s_cmp_ge_u32 s52, 400000
    s_cbranch_scc1 M_GN0_X
    s_waitcnt lgkmcnt(0)
    v_cmp_gt_u32 vcc, 1, v9
    s_cbranch_vccz M_GN0_X
    s_sleep 2
    s_branch M_GN0_L
M_GN0_X:
    ds_read_b32 v6, v13 offset:28
    v_lshlrev_b32 v2, 4, v1
    s_lshl_b32 s56, s54, 1
    s_add_u32 s56, s56, 0
    s_mul_i32 s56, s56, 86
    s_mul_i32 s52, s24, 22
    s_add_u32 s56, s56, s52
    s_lshl_b32 s56, s56, 10
    s_add_u32 s56, s56, 12582912
    s_mov_b32 s52, 0
M_VX11_L:
    ds_read_b32 v9, v8 offset:0
    s_add_u32 s52, s52, 1
    s_cmp_ge_u32 s52, 400000
    s_cbranch_scc1 M_VX11_X
    s_waitcnt lgkmcnt(0)
    v_cmp_gt_u32 vcc, 11, v9
    s_cbranch_vccz M_VX11_X
    s_sleep 4
    s_branch M_VX11_L
M_VX11_X:
    s_add_u32 m0, s62, 81920
    s_add_u32 s52, s57, 98304
    buffer_load_dwordx4 v4, s[12:15], s52 offen lds
    s_add_u32 m0, s62, 82944
    s_add_u32 s52, s57, 106496
    buffer_load_dwordx4 v4, s[12:15], s52 offen lds
    s_mov_b32 s52, 0
M_VX12_L:
    ds_read_b32 v9, v8 offset:0
    s_add_u32 s52, s52, 1
    s_cmp_ge_u32 s52, 400000
    s_cbranch_scc1 M_VX12_X
    s_waitcnt lgkmcnt(0)
    v_cmp_gt_u32 vcc, 12, v9
    s_cbranch_vccz M_VX12_X
    s_sleep 4
    s_branch M_VX12_L
M_VX12_X:
    s_add_u32 m0, s62, 90112
    s_add_u32 s52, s57, 114688
    buffer_load_dwordx4 v4, s[12:15], s52 offen lds
    s_add_u32 m0, s62, 91136
    s_add_u32 s52, s57, 122880
    buffer_load_dwordx4 v4, s[12:15], s52 offen lds
    s_add_u32 m0, s62, 98304
    s_add_u32 s52, s57, 131072
    buffer_load_dwordx4 v4, s[12:15], s52 offen lds
    s_add_u32 m0, s62, 99328
    s_add_u32 s52, s57, 139264
    buffer_load_dwordx4 v4, s[12:15], s52 offen lds
    s_add_u32 m0, s62, 16384
    s_add_u32 s52, s57, 180224
    buffer_load_dwordx4 v4, s[12:15], s52 offen lds
    s_add_u32 m0, s62, 17408
    s_add_u32 s52, s57, 188416
    buffer_load_dwordx4 v4, s[12:15], s52 offen lds
    s_mov_b32 s52, 0
M_VX13_L:
    ds_read_b32 v9, v8 offset:0
    s_add_u32 s52, s52, 1
    s_cmp_ge_u32 s52, 400000
    s_cbranch_scc1 M_VX13_X
    s_waitcnt lgkmcnt(0)
    v_cmp_gt_u32 vcc, 13, v9
    s_cbranch_vccz M_VX13_X
    s_sleep 4
    s_branch M_VX13_L
M_VX13_X:
    s_add_u32 m0, s62, 32768
    s_add_u32 s52, s57, 0
    buffer_load_dwordx4 v4, s[12:15], s52 offen lds
    s_add_u32 m0, s62, 33792
    s_add_u32 s52, s57, 8192
    buffer_load_dwordx4 v4, s[12:15], s52 offen lds
    s_add_u32 m0, s62, 24576
    s_add_u32 s52, s57, 196608
    buffer_load_dwordx4 v4, s[12:15], s52 offen lds
    s_add_u32 m0, s62, 25600
    s_add_u32 s52, s57, 204800
    buffer_load_dwordx4 v4, s[12:15], s52 offen lds
    s_mov_b32 s52, 0
M_VX14_L:
    ds_read_b32 v9, v8 offset:0
    s_add_u32 s52, s52, 1
    s_cmp_ge_u32 s52, 400000
    s_cbranch_scc1 M_VX14_X
    s_waitcnt lgkmcnt(0)
    v_cmp_gt_u32 vcc, 14, v9
    s_cbranch_vccz M_VX14_X
    s_sleep 4
    s_branch M_VX14_L
M_VX14_X:
    s_add_u32 m0, s62, 40960
    s_add_u32 s52, s57, 16384
    buffer_load_dwordx4 v4, s[12:15], s52 offen lds
    s_add_u32 m0, s62, 41984
    s_add_u32 s52, s57, 24576
    buffer_load_dwordx4 v4, s[12:15], s52 offen lds
    s_mov_b32 s52, 0
M_VX15_L:
    ds_read_b32 v9, v8 offset:0
    s_add_u32 s52, s52, 1
    s_cmp_ge_u32 s52, 400000
    s_cbranch_scc1 M_VX15_X
    s_waitcnt lgkmcnt(0)
    v_cmp_gt_u32 vcc, 15, v9
    s_cbranch_vccz M_VX15_X
    s_sleep 4
    s_branch M_VX15_L
M_VX15_X:
    s_add_u32 m0, s62, 49152
    s_add_u32 s52, s57, 32768
    buffer_load_dwordx4 v4, s[12:15], s52 offen lds
    s_add_u32 m0, s62, 50176
    s_add_u32 s52, s57, 40960
    buffer_load_dwordx4 v4, s[12:15], s52 offen lds
    s_add_u32 m0, s62, 57344
    s_add_u32 s52, s57, 49152
    buffer_load_dwordx4 v4, s[12:15], s52 offen lds
    s_add_u32 m0, s62, 58368
    s_add_u32 s52, s57, 57344
    buffer_load_dwordx4 v4, s[12:15], s52 offen lds
    s_mov_b32 s52, 0
M_VX16_L:
    ds_read_b32 v9, v8 offset:0
    s_add_u32 s52, s52, 1
    s_cmp_ge_u32 s52, 400000
    s_cbranch_scc1 M_VX16_X
    s_waitcnt lgkmcnt(0)
    v_cmp_gt_u32 vcc, 16, v9
    s_cbranch_vccz M_VX16_X
    s_sleep 4
    s_branch M_VX16_L
M_VX16_X:
    s_add_u32 m0, s62, 65536
    s_add_u32 s52, s57, 65536
    buffer_load_dwordx4 v4, s[12:15], s52 offen lds
    s_add_u32 m0, s62, 66560
    s_add_u32 s52, s57, 73728
    buffer_load_dwordx4 v4, s[12:15], s52 offen lds
    s_add_u32 m0, s62, 73728
    s_add_u32 s52, s57, 81920
    buffer_load_dwordx4 v4, s[12:15], s52 offen lds
    s_add_u32 m0, s62, 74752
    s_add_u32 s52, s57, 90112
    buffer_load_dwordx4 v4, s[12:15], s52 offen lds
    s_add_u32 m0, s62, 0
    s_add_u32 s52, s57, 147456
    buffer_load_dwordx4 v4, s[12:15], s52 offen lds
    s_add_u32 m0, s62, 1024
    s_add_u32 s52, s57, 155648
    buffer_load_dwordx4 v4, s[12:15], s52 offen lds
    s_add_u32 m0, s62, 8192
    s_add_u32 s52, s57, 163840
    buffer_load_dwordx4 v4, s[12:15], s52 offen lds
    s_add_u32 m0, s62, 9216
    s_add_u32 s52, s57, 172032
    buffer_load_dwordx4 v4, s[12:15], s52 offen lds
    s_waitcnt vmcnt(0)
    v_mov_b32 v9, 20
    ds_write_b32 v7, v9
    ds_read_b64_tr_b16 v[96:97], v5 offset:32768
    ds_read_b64_tr_b16 v[98:99], v5 offset:33280
    ds_read_b64_tr_b16 v[100:101], v10 offset:32768
    ds_read_b64_tr_b16 v[102:103], v10 offset:33280
    ds_read_b64_tr_b16 v[104:105], v5 offset:40960
    ds_read_b64_tr_b16 v[106:107], v5 offset:41472
    ds_read_b64_tr_b16 v[108:109], v10 offset:40960
    ds_read_b64_tr_b16 v[110:111], v10 offset:41472
    ds_read_b64_tr_b16 v[112:113], v5 offset:49152
    ds_read_b64_tr_b16 v[114:115], v5 offset:49664
    ds_read_b64_tr_b16 v[116:117], v10 offset:49152
    ds_read_b64_tr_b16 v[118:119], v10 offset:49664
    ds_read_b64_tr_b16 v[120:121], v14 offset:0
    ds_read_b64_tr_b16 v[122:123], v14 offset:512
    ds_read_b64_tr_b16 v[124:125], v15 offset:0
    ds_read_b64_tr_b16 v[126:127], v15 offset:512
    ds_read_b64_tr_b16 v[128:129], v14 offset:8192
    ds_read_b64_tr_b16 v[130:131], v14 offset:8704
    ds_read_b64_tr_b16 v[132:133], v15 offset:8192
    ds_read_b64_tr_b16 v[134:135], v15 offset:8704
    ds_read_b64_tr_b16 v[136:137], v14 offset:16384
    ds_read_b64_tr_b16 v[138:139], v14 offset:16896
    ds_read_b64_tr_b16 v[140:141], v15 offset:16384
    ds_read_b64_tr_b16 v[142:143], v15 offset:16896
    ds_read_b64_tr_b16 v[144:145], v14 offset:24576
    ds_read_b64_tr_b16 v[146:147], v14 offset:25088
    ds_read_b64_tr_b16 v[148:149], v15 offset:24576
    ds_read_b64_tr_b16 v[150:151], v15 offset:25088
    ds_read_b64_tr_b16 v[152:153], v14 offset:32768
    ds_read_b64_tr_b16 v[154:155], v14 offset:33280
    ds_read_b64_tr_b16 v[156:157], v15 offset:32768
    ds_read_b64_tr_b16 v[158:159], v15 offset:33280
    ds_read_b64_tr_b16 v[160:161], v14 offset:40960
    ds_read_b64_tr_b16 v[162:163], v14 offset:41472
    ds_read_b64_tr_b16 v[164:165], v15 offset:40960
    ds_read_b64_tr_b16 v[166:167], v15 offset:41472
    s_mov_b32 s52, 0
M_VY_L:
    ds_read_b32 v9, v11 offset:0
    s_add_u32 s52, s52, 1
    s_cmp_ge_u32 s52, 400000
    s_cbranch_scc1 M_VY_X
    s_waitcnt lgkmcnt(0)
    v_cmp_gt_u32 vcc, 20, v9
    s_cbranch_vccz M_VY_X
    s_sleep 1
    s_branch M_VY_L
M_VY_X:
    s_add_u32 m0, s62, 32768
    s_add_u32 s52, s57, 212992
    buffer_load_dwordx4 v4, s[12:15], s52 offen lds
    s_add_u32 m0, s62, 33792
    s_add_u32 s52, s57, 221184
    buffer_load_dwordx4 v4, s[12:15], s52 offen lds
    s_add_u32 m0, s62, 40960
    s_add_u32 s52, s57, 229376
    buffer_load_dwordx4 v4, s[12:15], s52 offen lds
    s_add_u32 m0, s62, 41984
    s_add_u32 s52, s57, 237568
    buffer_load_dwordx4 v4, s[12:15], s52 offen lds
    s_add_u32 m0, s62, 49152
    s_add_u32 s52, s57, 245760
    buffer_load_dwordx4 v4, s[12:15], s52 offen lds
    s_add_u32 m0, s62, 50176
    s_add_u32 s52, s57, 253952
    buffer_load_dwordx4 v4, s[12:15], s52 offen lds
    s_add_u32 m0, s62, 57344
    s_add_u32 s52, s57, 262144
    buffer_load_dwordx4 v4, s[12:15], s52 offen lds
    s_add_u32 m0, s62, 58368
    s_add_u32 s52, s57, 270336
    buffer_load_dwordx4 v4, s[12:15], s52 offen lds
    s_add_u32 m0, s62, 65536
    s_add_u32 s52, s57, 278528
    buffer_load_dwordx4 v4, s[12:15], s52 offen lds
    s_add_u32 m0, s62, 66560
    s_add_u32 s52, s57, 286720
    buffer_load_dwordx4 v4, s[12:15], s52 offen lds
    s_add_u32 m0, s62, 73728
    s_add_u32 s52, s57, 294912
    buffer_load_dwordx4 v4, s[12:15], s52 offen lds
    s_add_u32 m0, s62, 74752
    s_add_u32 s52, s57, 303104
    buffer_load_dwordx4 v4, s[12:15], s52 offen lds
    s_add_u32 m0, s62, 81920
    s_add_u32 s52, s57, 311296
    buffer_load_dwordx4 v4, s[12:15], s52 offen lds
    s_add_u32 m0, s62, 82944
    s_add_u32 s52, s57, 319488
    buffer_load_dwordx4 v4, s[12:15], s52 offen lds
    s_add_u32 m0, s62, 90112
    s_add_u32 s52, s57, 327680
    buffer_load_dwordx4 v4, s[12:15], s52 offen lds
    s_add_u32 m0, s62, 91136
    s_add_u32 s52, s57, 335872
    buffer_load_dwordx4 v4, s[12:15], s52 offen lds
    s_add_u32 m0, s62, 98304
    s_add_u32 s52, s57, 344064
    buffer_load_dwordx4 v4, s[12:15], s52 offen lds
    s_add_u32 m0, s62, 99328
    s_add_u32 s52, s57, 352256
    buffer_load_dwordx4 v4, s[12:15], s52 offen lds
M_G2W:
    s_lshl_b32 s52, s24, 3
    s_lshr_b32 s53, 0x0b070300, s52
    s_and_b32 s53, s53, 255
    s_lshr_b32 s88, 0x03070703, s52
    s_and_b32 s88, s88, 255
    s_mov_b32 s89, 0
    s_lshr_b32 s90, 0x0f0f1f0f, s52
    s_and_b32 s90, s90, 255
    s_mov_b32 s91, 0
    s_lshr_b32 s60, s54, 1
    s_lshl_b32 s60, s60, 4
    s_add_u32 s60, s60, s53
    s_lshl_b32 s60, s60, 7
    s_add_u32 s60, s60, 28311560
    s_mov_b32 s8, s32
    s_mov_b32 s9, s33
    s_mov_b32 s10, 0x200000
    s_mov_b32 s11, 0x00020000
    s_mov_b32 s16, s46
    s_mov_b32 s17, s47
    s_mov_b32 s18, 0x200000
    s_mov_b32 s19, 0x00020000
    s_lshl_b32 s58, s54, 1
    s_add_u32 s58, s58, s63
    s_lshl_b32 s58, s58, 2
    s_add_u32 s58, s58, s24
    s_lshl_b32 s58, s58, 13
    s_lshl_b32 s52, s55, 7
    s_add_u32 s58, s58, s52
    s_lshl_b32 s59, s58, 1
    s_add_u32 s59, s59, 18874368
    v_lshrrev_b32 v19, 3, v1
    v_and_b32 v4, 7, v1
    v_lshlrev_b32 v16, 10, v19
    v_lshl_add_u32 v16, v4, 4, v16
    v_lshlrev_b32 v4, 1, v4
    v_xor_b32 v4, v4, v19
    v_lshlrev_b32 v4, 4, v4
    v_lshl_add_u32 v18, v19, 8, v4
    s_lshl_b32 s52, s63, 2
    s_add_u32 s52, s52, s24
    s_lshl_b32 s52, s52, 13
    s_add_u32 s52, s52, 57344
    v_add_u32 v18, s52, v18
    v_and_b32 v19, 3, v19
    v_lshlrev_b32 v17, 13, v19
    v_and_b32 v19, 7, v1
    v_lshl_add_u32 v17, v19, 8, v17
    v_lshrrev_b32 v4, 5, v1
    v_lshlrev_b32 v4, 2, v4
    v_xor_b32 v4, v4, v19
    v_lshl_add_u32 v17, v4, 4, v17
    s_lshl_b32 s52, s63, 15
    s_add_u32 s52, s52, s62
    v_add_u32 v17, s52, v17
    v_lshlrev_b32 v19, 7, v1
    s_mov_b64 exec, s[90:91]
    s_mov_b32 s52, 0
M_G2P_L:
    buffer_load_dword v4, v19, s[4:7], s60 offen sc1
    s_waitcnt vmcnt(0)
    v_cmp_ne_u32 vcc, v6, v4
    s_nop 4
    s_mov_b64 exec, vcc
    s_mov_b64 s[90:91], vcc
    s_and_b64 vcc, vcc, s[88:89]
    s_add_u32 s52, s52, 1
    s_cmp_ge_u32 s52, 100000
    s_cbranch_scc1 M_G2P_X
    s_nop 3
    s_cmp_eq_u64 vcc, 0
    s_cbranch_scc1 M_G2P_X
    s_sleep 1
    s_branch M_G2P_L
M_G2P_X:
    s_mov_b64 exec, -1
    s_cmp_lg_u32 s90, 0
    s_cbranch_scc1 M_G2L2
    buffer_load_dwordx4 v[20:23], v2, s[4:7], s56 offen offset:0
    buffer_load_dwordx4 v[24:27], v2, s[4:7], s56 offen offset:1024
    buffer_load_dwordx4 v[28:31], v2, s[4:7], s56 offen offset:2048
    buffer_load_dwordx4 v[32:35], v2, s[4:7], s56 offen offset:3072
    s_add_u32 s53, s56, 4096
    buffer_load_dwordx4 v[36:39], v2, s[4:7], s53 offen offset:0
    buffer_load_dwordx4 v[40:43], v2, s[4:7], s53 offen offset:1024
    buffer_load_dwordx4 v[44:47], v2, s[4:7], s53 offen offset:2048
    buffer_load_dwordx4 v[48:51], v2, s[4:7], s53 offen offset:3072
    s_add_u32 s53, s56, 8192
    buffer_load_dwordx4 v[52:55], v2, s[4:7], s53 offen offset:0
    buffer_load_dwordx4 v[56:59], v2, s[4:7], s53 offen offset:1024
    buffer_load_dwordx4 v[60:63], v2, s[4:7], s53 offen offset:2048
    s_waitcnt vmcnt(10)
    v_mov_b32 v9, 21
    ds_write_b32 v7, v9
    v_mfma_f32_32x32x16_bf16 v[64:79], v[96:99], v[20:23], 0
    v_mfma_f32_32x32x16_bf16 v[80:95], v[100:103], v[20:23], 0
    buffer_load_dwordx4 v[20:23], v2, s[4:7], s53 offen offset:3072
    s_add_u32 s53, s56, 12288
    buffer_load_dwordx4 v[96:99], v2, s[4:7], s53 offen offset:0
    buffer_load_dwordx4 v[100:103], v2, s[4:7], s53 offen offset:1024
    s_waitcnt vmcnt(12)
    v_mfma_f32_32x32x16_bf16 v[64:79], v[104:107], v[24:27], v[64:79]
    v_mfma_f32_32x32x16_bf16 v[80:95], v[108:111], v[24:27], v[80:95]
    buffer_load_dwordx4 v[24:27], v2, s[4:7], s53 offen offset:2048
    buffer_load_dwordx4 v[104:107], v2, s[4:7], s53 offen offset:3072
    s_add_u32 s53, s56, 16384
    buffer_load_dwordx4 v[108:111], v2, s[4:7], s53 offen offset:0
    s_waitcnt vmcnt(14)
    v_mfma_f32_32x32x16_bf16 v[64:79], v[112:115], v[28:31], v[64:79]
    v_mfma_f32_32x32x16_bf16 v[80:95], v[116:119], v[28:31], v[80:95]
    buffer_load_dwordx4 v[28:31], v2, s[4:7], s53 offen offset:1024
    buffer_load_dwordx4 v[112:115], v2, s[4:7], s53 offen offset:2048
    buffer_load_dwordx4 v[116:119], v2, s[4:7], s53 offen offset:3072
    s_waitcnt vmcnt(16)
    v_mfma_f32_32x32x16_bf16 v[64:79], v[120:123], v[32:35], v[64:79]
    v_mfma_f32_32x32x16_bf16 v[80:95], v[124:127], v[32:35], v[80:95]
    s_add_u32 s53, s56, 20480
    s_cmp_eq_u32 s24, 3
    s_cselect_b32 s52, 4096, 0
    s_sub_u32 s53, s53, s52
    buffer_load_dwordx4 v[32:35], v2, s[4:7], s53 offen offset:0
    s_waitcnt vmcnt(16)
    v_mfma_f32_32x32x16_bf16 v[64:79], v[128:131], v[36:39], v[64:79]
    v_mfma_f32_32x32x16_bf16 v[80:95], v[132:135], v[36:39], v[80:95]
    buffer_load_dwordx4 v[36:39], v2, s[4:7], s53 offen offset:1024
    s_waitcnt vmcnt(16)
    v_mfma_f32_32x32x16_bf16 v[64:79], v[136:139], v[40:43], v[64:79]
    v_mfma_f32_32x32x16_bf16 v[80:95], v[140:143], v[40:43], v[80:95]
    ds_read_b64_tr_b16 v[120:121], v5 offset:0
    ds_read_b64_tr_b16 v[122:123], v5 offset:512
    ds_read_b64_tr_b16 v[124:125], v10 offset:0
    ds_read_b64_tr_b16 v[126:127], v10 offset:512
    s_waitcnt vmcnt(15)
    v_mfma_f32_32x32x16_bf16 v[64:79], v[144:147], v[44:47], v[64:79]
    v_mfma_f32_32x32x16_bf16 v[80:95], v[148:151], v[44:47], v[80:95]
    ds_read_b64_tr_b16 v[128:129], v5 offset:8192
    ds_read_b64_tr_b16 v[130:131], v5 offset:8704
    ds_read_b64_tr_b16 v[132:133], v10 offset:8192
    ds_read_b64_tr_b16 v[134:135], v10 offset:8704
    s_waitcnt vmcnt(14)
    v_mfma_f32_32x32x16_bf16 v[64:79], v[152:155], v[48:51], v[64:79]
    v_mfma_f32_32x32x16_bf16 v[80:95], v[156:159], v[48:51], v[80:95]
    ds_read_b64_tr_b16 v[136:137], v5 offset:16384
    ds_read_b64_tr_b16 v[138:139], v5 offset:16896
    ds_read_b64_tr_b16 v[140:141], v10 offset:16384
    ds_read_b64_tr_b16 v[142:143], v10 offset:16896
    s_waitcnt vmcnt(13)
    v_mfma_f32_32x32x16_bf16 v[64:79], v[160:163], v[52:55], v[64:79]
    v_mfma_f32_32x32x16_bf16 v[80:95], v[164:167], v[52:55], v[80:95]
    ds_read_b64_tr_b16 v[144:145], v5 offset:24576
    ds_read_b64_tr_b16 v[146:147], v5 offset:25088
    ds_read_b64_tr_b16 v[148:149], v10 offset:24576
    ds_read_b64_tr_b16 v[150:151], v10 offset:25088
    s_waitcnt vmcnt(12)
    s_waitcnt lgkmcnt(12)
    v_mfma_f32_32x32x16_bf16 v[64:79], v[120:123], v[56:59], v[64:79]
    v_mfma_f32_32x32x16_bf16 v[80:95], v[124:127], v[56:59], v[80:95]
    s_mov_b32 s52, 0
M_G2VA_L:
    ds_read_b32 v9, v12 offset:0
    s_add_u32 s52, s52, 1
    s_cmp_ge_u32 s52, 400000
    s_cbranch_scc1 M_G2VA_X
    s_waitcnt lgkmcnt(0)
    v_cmp_gt_u32 vcc, 21, v9
    s_cbranch_vccnz M_G2VA_L
M_G2VA_X:
    ds_read_b64_tr_b16 v[152:153], v5 offset:32768
    ds_read_b64_tr_b16 v[154:155], v5 offset:33280
    ds_read_b64_tr_b16 v[156:157], v10 offset:32768
    ds_read_b64_tr_b16 v[158:159], v10 offset:33280
    s_waitcnt vmcnt(11)
    s_waitcnt lgkmcnt(12)
    v_mfma_f32_32x32x16_bf16 v[64:79], v[128:131], v[60:63], v[64:79]
    v_mfma_f32_32x32x16_bf16 v[80:95], v[132:135], v[60:63], v[80:95]
    buffer_load_dwordx4 v[60:63], v16, s[8:11], s58 offen
    ds_read_b64_tr_b16 v[160:161], v5 offset:40960
    ds_read_b64_tr_b16 v[162:163], v5 offset:41472
    ds_read_b64_tr_b16 v[164:165], v10 offset:40960
    ds_read_b64_tr_b16 v[166:167], v10 offset:41472
    s_waitcnt vmcnt(11)
    s_waitcnt lgkmcnt(12)
    v_mfma_f32_32x32x16_bf16 v[64:79], v[136:139], v[20:23], v[64:79]
    v_mfma_f32_32x32x16_bf16 v[80:95], v[140:143], v[20:23], v[80:95]
    ds_read_b64_tr_b16 v[120:121], v5 offset:49152
    ds_read_b64_tr_b16 v[122:123], v5 offset:49664
    ds_read_b64_tr_b16 v[124:125], v10 offset:49152
    ds_read_b64_tr_b16 v[126:127], v10 offset:49664
    s_waitcnt vmcnt(10)
    s_waitcnt lgkmcnt(12)
    v_mfma_f32_32x32x16_bf16 v[64:79], v[144:147], v[96:99], v[64:79]
    v_mfma_f32_32x32x16_bf16 v[80:95], v[148:151], v[96:99], v[80:95]
    ds_read_b64_tr_b16 v[128:129], v14 offset:0
    ds_read_b64_tr_b16 v[130:131], v14 offset:512
    ds_read_b64_tr_b16 v[132:133], v15 offset:0
    ds_read_b64_tr_b16 v[134:135], v15 offset:512
    v_mov_b32 v9, 22
    ds_write_b32 v7, v9
    s_waitcnt vmcnt(9)
    s_waitcnt lgkmcnt(13)
    v_mfma_f32_32x32x16_bf16 v[64:79], v[152:155], v[100:103], v[64:79]
    v_mfma_f32_32x32x16_bf16 v[80:95], v[156:159], v[100:103], v[80:95]
    ds_read_b64_tr_b16 v[136:137], v14 offset:8192
    ds_read_b64_tr_b16 v[138:139], v14 offset:8704
    ds_read_b64_tr_b16 v[140:141], v15 offset:8192
    ds_read_b64_tr_b16 v[142:143], v15 offset:8704
    s_waitcnt vmcnt(8)
    s_waitcnt lgkmcnt(13)
    v_mfma_f32_32x32x16_bf16 v[64:79], v[160:163], v[24:27], v[64:79]
    v_mfma_f32_32x32x16_bf16 v[80:95], v[164:167], v[24:27], v[80:95]
    ds_read_b64_tr_b16 v[144:145], v14 offset:16384
    ds_read_b64_tr_b16 v[146:147], v14 offset:16896
    ds_read_b64_tr_b16 v[148:149], v15 offset:16384
    ds_read_b64_tr_b16 v[150:151], v15 offset:16896
    s_waitcnt vmcnt(7)
    s_waitcnt lgkmcnt(13)
    v_mfma_f32_32x32x16_bf16 v[64:79], v[120:123], v[104:107], v[64:79]
    v_mfma_f32_32x32x16_bf16 v[80:95], v[124:127], v[104:107], v[80:95]
    ds_read_b64_tr_b16 v[152:153], v14 offset:24576
    ds_read_b64_tr_b16 v[154:155], v14 offset:25088
    ds_read_b64_tr_b16 v[156:157], v15 offset:24576
    ds_read_b64_tr_b16 v[158:159], v15 offset:25088
    s_waitcnt vmcnt(6)
    s_waitcnt lgkmcnt(13)
    v_mfma_f32_32x32x16_bf16 v[64:79], v[128:131], v[108:111], v[64:79]
    v_mfma_f32_32x32x16_bf16 v[80:95], v[132:135], v[108:111], v[80:95]
    ds_read_b64_tr_b16 v[160:161], v14 offset:32768
    ds_read_b64_tr_b16 v[162:163], v14 offset:33280
    ds_read_b64_tr_b16 v[164:165], v15 offset:32768
    ds_read_b64_tr_b16 v[166:167], v15 offset:33280
    s_waitcnt vmcnt(5)
    s_waitcnt lgkmcnt(12)
    v_mfma_f32_32x32x16_bf16 v[64:79], v[136:139], v[28:31], v[64:79]
    v_mfma_f32_32x32x16_bf16 v[80:95], v[140:143], v[28:31], v[80:95]
    ds_read_b64_tr_b16 v[120:121], v14 offset:40960
    ds_read_b64_tr_b16 v[122:123], v14 offset:41472
    ds_read_b64_tr_b16 v[124:125], v15 offset:40960
    ds_read_b64_tr_b16 v[126:127], v15 offset:41472
    s_waitcnt vmcnt(4)
    s_waitcnt lgkmcnt(12)
    v_mfma_f32_32x32x16_bf16 v[64:79], v[144:147], v[112:115], v[64:79]
    v_mfma_f32_32x32x16_bf16 v[80:95], v[148:151], v[112:115], v[80:95]
    s_waitcnt vmcnt(3)
    s_waitcnt lgkmcnt(8)
    v_mfma_f32_32x32x16_bf16 v[64:79], v[152:155], v[116:119], v[64:79]
    v_mfma_f32_32x32x16_bf16 v[80:95], v[156:159], v[116:119], v[80:95]
    s_waitcnt vmcnt(2)
    s_waitcnt lgkmcnt(4)
    s_cmp_eq_u32 s24, 3
    s_cbranch_scc1 M_G2E
    v_mfma_f32_32x32x16_bf16 v[64:79], v[160:163], v[32:35], v[64:79]
    v_mfma_f32_32x32x16_bf16 v[80:95], v[164:167], v[32:35], v[80:95]
    s_waitcnt vmcnt(1)
    s_waitcnt lgkmcnt(0)
    v_mfma_f32_32x32x16_bf16 v[64:79], v[120:123], v[36:39], v[64:79]
    v_mfma_f32_32x32x16_bf16 v[80:95], v[124:127], v[36:39], v[80:95]
M_G2E:
    s_waitcnt lgkmcnt(0)
    v_lshlrev_b32 v152, 1, v16
    s_mov_b32 s52, 0
M_G2Q_L:
    ds_read_b32 v9, v11 offset:0
    s_add_u32 s52, s52, 1
    s_cmp_ge_u32 s52, 400000
    s_cbranch_scc1 M_G2Q_X
    s_waitcnt lgkmcnt(0)
    v_cmp_gt_u32 vcc, 22, v9
    s_cbranch_vccnz M_G2Q_L
M_G2Q_X:
    v_xor_b32 v19, 16, v17
    v_xor_b32 v4, 32, v17
    v_xor_b32 v5, 48, v17
    ds_write_b128 v17, v[64:67] offset:0
    ds_write_b128 v19, v[68:71] offset:0
    ds_write_b128 v4, v[72:75] offset:0
    ds_write_b128 v5, v[76:79] offset:0
    ds_write_b128 v17, v[80:83] offset:128
    ds_write_b128 v19, v[84:87] offset:128
    ds_write_b128 v4, v[88:91] offset:128
    ds_write_b128 v5, v[92:95] offset:128
    s_lshl_b32 s53, s63, 2
    v_add_u32 v10, s53, v13
    v_xor_b32 v17, 16, v18
    s_mov_b32 s60, 0xbfb8aa3b
    s_mov_b32 s61, 0xbfb8aa3b
    s_mov_b32 s54, 0x3f800000
    s_mov_b32 s55, 0x3f800000
    s_mov_b32 s56, 0xffff0000
    v_mov_b32 v9, 1
    s_mov_b64 exec, 1
    ds_add_rtn_u32 v9, v10, v9 offset:16
    s_mov_b64 exec, -1
    s_waitcnt lgkmcnt(0)
    v_readfirstlane_b32 s52, v9
    s_cmp_eq_u32 s52, 3
    s_cbranch_scc1 M_G2B_X
    s_mov_b32 s52, 0
M_G2B_L:
    ds_read_b32 v9, v10 offset:16
    s_add_u32 s52, s52, 1
    s_cmp_ge_u32 s52, 400000
    s_cbranch_scc1 M_G2B_X
    s_waitcnt lgkmcnt(0)
    v_cmp_gt_u32 vcc, 4, v9
    s_cbranch_vccnz M_G2B_L
M_G2B_X:
    ds_read_b128 v[96:99], v18 offset:0
    ds_read_b128 v[100:103], v17 offset:0
    ds_read_b128 v[104:107], v18 offset:2048
    ds_read_b128 v[108:111], v17 offset:2048
    ds_read_b128 v[112:115], v18 offset:4096
    ds_read_b128 v[116:119], v17 offset:4096
    ds_read_b128 v[120:123], v18 offset:6144
    ds_read_b128 v[124:127], v17 offset:6144
    s_waitcnt vmcnt(0)
    v_lshlrev_b32 v128, 16, v60
    v_and_b32 v129, s56, v60
    v_lshlrev_b32 v130, 16, v61
    v_and_b32 v131, s56, v61
    v_lshlrev_b32 v132, 16, v62
    v_and_b32 v133, s56, v62
    v_lshlrev_b32 v134, 16, v63
    v_and_b32 v135, s56, v63
    s_waitcnt lgkmcnt(4)
    v_pk_add_f32 v[96:97], v[96:97], v[104:105]
    v_pk_add_f32 v[98:99], v[98:99], v[106:107]
    v_pk_add_f32 v[100:101], v[100:101], v[108:109]
    v_pk_add_f32 v[102:103], v[102:103], v[110:111]
    s_waitcnt lgkmcnt(0)
    v_pk_add_f32 v[112:113], v[112:113], v[120:121]
    v_pk_add_f32 v[114:115], v[114:115], v[122:123]
    v_pk_add_f32 v[116:117], v[116:117], v[124:125]
    v_pk_add_f32 v[118:119], v[118:119], v[126:127]
    v_pk_add_f32 v[96:97], v[96:97], v[112:113]
    v_pk_add_f32 v[98:99], v[98:99], v[114:115]
    v_pk_add_f32 v[100:101], v[100:101], v[116:117]
    v_pk_add_f32 v[102:103], v[102:103], v[118:119]
    v_cvt_pk_bf16_f32 v96, 0, v96
    v_cvt_pk_bf16_f32 v97, 0, v97
    v_cvt_pk_bf16_f32 v98, 0, v98
    v_cvt_pk_bf16_f32 v99, 0, v99
    v_cvt_pk_bf16_f32 v100, 0, v100
    v_cvt_pk_bf16_f32 v101, 0, v101
    v_cvt_pk_bf16_f32 v102, 0, v102
    v_cvt_pk_bf16_f32 v103, 0, v103
    v_pk_mul_f32 v[104:105], v[96:97], s[60:61]
    v_pk_mul_f32 v[106:107], v[98:99], s[60:61]
    v_pk_mul_f32 v[108:109], v[100:101], s[60:61]
    v_pk_mul_f32 v[110:111], v[102:103], s[60:61]
    v_exp_f32 v104, v104
    v_exp_f32 v105, v105
    v_exp_f32 v106, v106
    v_exp_f32 v107, v107
    v_exp_f32 v108, v108
    v_exp_f32 v109, v109
    v_exp_f32 v110, v110
    v_exp_f32 v111, v111
    v_pk_add_f32 v[104:105], v[104:105], s[54:55]
    v_pk_add_f32 v[106:107], v[106:107], s[54:55]
    v_pk_add_f32 v[108:109], v[108:109], s[54:55]
    v_pk_add_f32 v[110:111], v[110:111], s[54:55]
    v_rcp_f32 v104, v104
    v_rcp_f32 v105, v105
    v_rcp_f32 v106, v106
    v_rcp_f32 v107, v107
    v_rcp_f32 v108, v108
    v_rcp_f32 v109, v109
    v_rcp_f32 v110, v110
    v_rcp_f32 v111, v111
    v_pk_mul_f32 v[96:97], v[96:97], v[104:105]
    v_pk_mul_f32 v[98:99], v[98:99], v[106:107]
    v_pk_mul_f32 v[100:101], v[100:101], v[108:109]
    v_pk_mul_f32 v[102:103], v[102:103], v[110:111]
    v_cvt_pk_bf16_f32 v96, 0, v96
    v_cvt_pk_bf16_f32 v97, 0, v97
    v_cvt_pk_bf16_f32 v98, 0, v98
    v_cvt_pk_bf16_f32 v99, 0, v99
    v_cvt_pk_bf16_f32 v100, 0, v100
    v_cvt_pk_bf16_f32 v101, 0, v101
    v_cvt_pk_bf16_f32 v102, 0, v102
    v_cvt_pk_bf16_f32 v103, 0, v103
    s_mov_b32 s57, 0x05040100
    s_mov_b32 s52, 0
M_SP_L:
    buffer_load_dwordx4 v[136:139], v152, s[4:7], s59 offen offset:0 sc1
    buffer_load_dwordx4 v[140:143], v152, s[4:7], s59 offen offset:16 sc1
    s_waitcnt vmcnt(1)
    v_perm_b32 v144, v137, v136, s57
    v_xor_b32 v144, v6, v144
    v_perm_b32 v145, v139, v138, s57
    v_xor_b32 v145, v6, v145
    s_waitcnt vmcnt(0)
    v_perm_b32 v146, v141, v140, s57
    v_xor_b32 v146, v6, v146
    v_perm_b32 v147, v143, v142, s57
    v_xor_b32 v147, v6, v147
    v_or3_b32 v144, v144, v145, v146
    v_or_b32 v144, v144, v147
    v_cmp_ne_u32 vcc, 0, v144
    s_nop 4
    s_mov_b64 exec, vcc
    s_add_u32 s52, s52, 1
    s_cmp_ge_u32 s52, 100000
    s_cbranch_scc1 M_SP_X
    s_nop 3
    s_cmp_eq_u64 vcc, 0
    s_cbranch_scc1 M_SP_X
    s_sleep 2
    s_branch M_SP_L
M_SP_X:
    s_mov_b64 exec, -1
    v_and_b32 v136, s56, v136
    v_and_b32 v137, s56, v137
    v_and_b32 v138, s56, v138
    v_and_b32 v139, s56, v139
    v_and_b32 v140, s56, v140
    v_and_b32 v141, s56, v141
    v_and_b32 v142, s56, v142
    v_and_b32 v143, s56, v143
    v_pk_mul_f32 v[96:97], v[96:97], v[136:137]
    v_pk_mul_f32 v[98:99], v[98:99], v[138:139]
    v_pk_mul_f32 v[100:101], v[100:101], v[140:141]
    v_pk_mul_f32 v[102:103], v[102:103], v[142:143]
    v_cvt_pk_bf16_f32 v96, 0, v96
    v_cvt_pk_bf16_f32 v97, 0, v97
    v_cvt_pk_bf16_f32 v98, 0, v98
    v_cvt_pk_bf16_f32 v99, 0, v99
    v_cvt_pk_bf16_f32 v100, 0, v100
    v_cvt_pk_bf16_f32 v101, 0, v101
    v_cvt_pk_bf16_f32 v102, 0, v102
    v_cvt_pk_bf16_f32 v103, 0, v103
    v_pk_add_f32 v[96:97], v[96:97], v[128:129]
    v_pk_add_f32 v[98:99], v[98:99], v[130:131]
    v_pk_add_f32 v[100:101], v[100:101], v[132:133]
    v_pk_add_f32 v[102:103], v[102:103], v[134:135]
    v_cvt_pk_bf16_f32 v148, v96, v97
    v_cvt_pk_bf16_f32 v149, v98, v99
    v_cvt_pk_bf16_f32 v150, v100, v101
    v_cvt_pk_bf16_f32 v151, v102, v103
    buffer_store_dwordx4 v[148:151], v16, s[16:19], s58 offen sc1
    s_endpgm
M_VSP:
    s_barrier
    s_lshl_b32 s52, s24, 8
    s_add_u32 s52, s52, 35008
    v_lshlrev_b32 v7, 2, v1
    v_add_u32 v7, s52, v7
    v_and_b32 v8, 3, v1
    v_mul_u32_u24 v8, 260, v8
    v_add_u32 v8, 36032, v8
    s_waitcnt lgkmcnt(0)
    s_sleep 100
    s_branch M_V2
M_F:
    s_setprio 2
    s_xor_b32 s29, s2, 6
    s_mov_b32 s3, 0
    v_mov_b32 v8, 0
    v_mov_b32 v9, 0
    v_mov_b32 v10, 0
    v_mov_b32 v11, 0
    v_mov_b32 v12, 0
    v_mov_b32 v13, 0
    v_mov_b32 v14, 0
    v_mov_b32 v15, 0
    v_mov_b32 v16, 0
    v_mov_b32 v17, 0
    v_mov_b32 v18, 0
    v_mov_b32 v19, 0
    v_mov_b32 v20, 0
    v_mov_b32 v21, 0
    v_mov_b32 v22, 0
    v_mov_b32 v23, 0
    s_lshl_b32 s54, s30, 4
    s_add_u32 s54, s54, s31
    s_lshl_b32 s52, s54, 13
    s_lshl_b32 s53, s24, 11
    s_add_u32 s52, s52, s53
    v_lshlrev_b32 v2, 1, v1
    v_mov_b32 v3, 0
    s_bfe_u32 s58, s2, 0x70001
    s_lshr_b32 s55, s58, 5
    s_bfe_u32 s60, s58, 0x10004
    s_lshl_b32 s60, s60, 10
    s_add_u32 s55, s55, s60
    s_and_b32 s60, s58, 15
    s_lshl_b32 s60, s60, 4
    s_add_u32 s55, s55, s60
    s_mul_i32 s55, s55, 514
    s_and_b32 s60, s2, 1
    s_lshl_b32 s60, s60, 7
    s_lshl_b32 s61, s24, 5
    s_add_u32 s60, s60, s61
    s_lshl_b32 s61, s60, 1
    s_add_u32 s55, s55, s61
    s_lshl_b32 s60, s60, 13
    s_lshl_b32 s58, s58, 6
    s_add_u32 s56, s58, s60
    s_add_u32 s56, s56, 4718592
    s_add_u32 s57, s56, 131072
    v_and_b32 v4, 3, v1
    v_lshrrev_b32 v5, 2, v1
    v_mul_u32_u24 v116, 2056, v4
    v_lshl_add_u32 v116, v5, 1, v116
    v_lshlrev_b32 v4, 4, v4
    v_lshl_add_u32 v117, v5, 13, v4
    s_barrier
    s_waitcnt lgkmcnt(0)
    s_mov_b32 s8, s32
    s_mov_b32 s9, s33
    s_mov_b32 s10, 0x200000
    s_mov_b32 s11, 0x00020000
    buffer_load_short_d16_hi v8, v2, s[8:11], s52 offen offset:0
    buffer_load_short_d16_hi v9, v2, s[8:11], s52 offen offset:1024
    buffer_load_short_d16_hi v10, v2, s[8:11], s52 offen offset:128
    buffer_load_short_d16_hi v11, v2, s[8:11], s52 offen offset:1152
    buffer_load_short_d16_hi v12, v2, s[8:11], s52 offen offset:256
    buffer_load_short_d16_hi v13, v2, s[8:11], s52 offen offset:1280
    buffer_load_short_d16_hi v14, v2, s[8:11], s52 offen offset:384
    buffer_load_short_d16_hi v15, v2, s[8:11], s52 offen offset:1408
    buffer_load_short_d16_hi v16, v2, s[8:11], s52 offen offset:512
    buffer_load_short_d16_hi v17, v2, s[8:11], s52 offen offset:1536
    buffer_load_short_d16_hi v18, v2, s[8:11], s52 offen offset:640
    buffer_load_short_d16_hi v19, v2, s[8:11], s52 offen offset:1664
    buffer_load_short_d16_hi v20, v2, s[8:11], s52 offen offset:768
    buffer_load_short_d16_hi v21, v2, s[8:11], s52 offen offset:1792
    buffer_load_short_d16_hi v22, v2, s[8:11], s52 offen offset:896
    buffer_load_short_d16_hi v23, v2, s[8:11], s52 offen offset:1920
    s_mov_b32 s12, s34
    s_mov_b32 s13, s35
    s_mov_b32 s14, 0x101000
    s_mov_b32 s15, 0x00020000
    s_mov_b32 s16, s36
    s_mov_b32 s17, s37
    s_mov_b32 s18, 0x101000
    s_mov_b32 s19, 0x00020000
    s_lshl_b32 s60, s54, 3
    s_lshl_b32 s61, s24, 1
    s_add_u32 s60, s60, s61
    v_and_b32 v4, 1, v1
    v_add_u32 v4, s60, v4
    v_mul_u32_u24 v122, 514, v4
    v_min_u32 v5, 2, v1
    v_and_b32 v5, 2, v5
    v_lshl_add_u32 v122, v5, 8, v122
    v_sub_u32 v5, 2048, v4
    v_cmp_gt_u32 vcc, 4, v1
    s_nop 1
    v_cndmask_b32 v4, v4, v5, vcc
    v_lshrrev_b32 v5, 1, v1
    v_add_u32 v5, 1, v5
    v_cndmask_b32 v5, 0, v5, vcc
    v_lshlrev_b32 v123, 13, v5
    v_and_b32 v5, 3, v4
    v_lshl_add_u32 v123, v5, 11, v123
    v_bfe_u32 v5, v4, 10, 1
    v_lshl_add_u32 v123, v5, 10, v123
    v_bfe_u32 v5, v4, 2, 6
    v_lshl_add_u32 v123, v5, 4, v123
    v_bfe_u32 v5, v4, 8, 2
    v_lshl_add_u32 v123, v5, 2, v123
    s_mov_b32 s4, s50
    s_mov_b32 s5, s51
    s_mov_b32 s6, 0x1c00000
    s_mov_b32 s7, 0x00020000
    s_mov_b32 s20, s48
    s_mov_b32 s21, s49
    s_mov_b32 s22, 0x100
    s_mov_b32 s23, 0x00020000
    v_lshrrev_b32 v4, 3, v1
    v_cvt_f32_u32 v5, v4
    v_mul_f32 v6, 0xbc800000, v5
    v_cos_f32 v32, v6
    v_sin_f32 v33, v6
    v_mul_f32 v6, 0xbd000000, v5
    v_cos_f32 v34, v6
    v_sin_f32 v35, v6
    v_mul_f32 v6, 0xbd400000, v5
    v_cos_f32 v36, v6
    v_sin_f32 v37, v6
    v_mul_f32 v6, 0xbd800000, v5
    v_cos_f32 v38, v6
    v_sin_f32 v39, v6
    v_mul_f32 v6, 0xbda00000, v5
    v_cos_f32 v40, v6
    v_sin_f32 v41, v6
    v_mul_f32 v6, 0xbdc00000, v5
    v_cos_f32 v42, v6
    v_sin_f32 v43, v6
    v_mul_f32 v6, 0xbde00000, v5
    v_cos_f32 v44, v6
    v_sin_f32 v45, v6
    v_and_b32 v4, 7, v1
    v_cvt_f32_u32 v4, v4
    v_mul_f32 v5, 0xbb000000, v5
    v_mov_b32 v6, v4
    v_mul_f32 v6, v6, v5
    v_cos_f32 v46, v6
    v_sin_f32 v47, v6
    v_add_f32 v6, 0x41000000, v4
    v_mul_f32 v6, v6, v5
    v_cos_f32 v48, v6
    v_sin_f32 v49, v6
    v_add_f32 v6, 0x41800000, v4
    v_mul_f32 v6, v6, v5
    v_cos_f32 v50, v6
    v_sin_f32 v51, v6
    v_add_f32 v6, 0x41c00000, v4
    v_mul_f32 v6, v6, v5
    v_cos_f32 v52, v6
    v_sin_f32 v53, v6
    v_add_f32 v6, 0x42000000, v4
    v_mul_f32 v6, v6, v5
    v_cos_f32 v54, v6
    v_sin_f32 v55, v6
    v_add_f32 v6, 0x42200000, v4
    v_mul_f32 v6, v6, v5
    v_cos_f32 v56, v6
    v_sin_f32 v57, v6
    v_add_f32 v6, 0x42400000, v4
    v_mul_f32 v6, v6, v5
    v_cos_f32 v58, v6
    v_sin_f32 v59, v6
    v_add_f32 v6, 0x42600000, v4
    v_mul_f32 v6, v6, v5
    v_cos_f32 v60, v6
    v_sin_f32 v61, v6
    s_mul_i32 s28, s24, 4608
    s_add_u32 s28, s28, s3
    v_and_b32 v4, 7, v1
    v_lshrrev_b32 v5, 3, v1
    v_mul_u32_u24 v84, 72, v4
    v_mul_u32_u24 v85, 576, v5
    v_add_u32 v84, v84, v85
    v_lshlrev_b32 v86, 3, v4
    v_add_u32 v86, v86, v85
    v_mul_u32_u24 v85, 72, v5
    v_lshlrev_b32 v4, 3, v4
    v_add_u32 v85, v85, v4
    v_lshlrev_b32 v87, 3, v1
    v_add_u32 v84, s28, v84
    v_add_u32 v85, s28, v85
    v_add_u32 v86, s28, v86
    v_add_u32 v87, s28, v87
    v_lshlrev_b32 v4, 1, v0
    v_cvt_f32_u32 v4, v4
    v_add_f32 v5, 1.0, v4
    v_mul_f32 v6, 0xba000000, v4
    v_cos_f32 v148, v6
    v_sin_f32 v149, v6
    v_mul_f32 v6, 0xba000000, v5
    v_cos_f32 v150, v6
    v_sin_f32 v151, v6
    v_mul_f32 v6, 0xba800000, v4
    v_cos_f32 v152, v6
    v_sin_f32 v153, v6
    v_mul_f32 v6, 0xba800000, v5
    v_cos_f32 v154, v6
    v_sin_f32 v155, v6
    v_mul_f32 v6, 0xbac00000, v4
    v_cos_f32 v156, v6
    v_sin_f32 v157, v6
    v_mul_f32 v6, 0xbac00000, v5
    v_cos_f32 v158, v6
    v_sin_f32 v159, v6
    v_mov_b32 v98, 34880
    v_sub_u32 v88, 320, v1
    v_lshlrev_b32 v88, 3, v88
    v_add_u32 v88, s28, v88
    v_lshrrev_b32 v4, 1, v1
    v_xor_b32 v4, s24, v4
    v_and_b32 v4, 3, v4
    v_lshlrev_b32 v4, 4, v4
    v_lshl_add_u32 v89, v1, 6, v4
    v_add_u32 v89, 18432, v89
    v_lshrrev_b32 v4, 3, v1
    v_xor_b32 v4, v4, v1
    v_and_b32 v4, 3, v4
    v_lshlrev_b32 v4, 4, v4
    v_lshrrev_b32 v5, 2, v1
    v_lshl_add_u32 v90, v5, 6, v4
    s_lshl_b32 s53, s24, 12
    s_add_u32 s53, s53, 18432
    v_add_u32 v90, s53, v90
    v_and_b32 v4, 3, v1
    v_lshlrev_b32 v4, 4, v4
    v_lshl_add_u32 v91, v5, 14, v4
    s_lshl_b32 s58, s24, 20
    s_lshl_b32 s53, s54, 6
    s_add_u32 s58, s58, s53
    s_add_u32 s59, s58, 262144
    s_add_u32 s60, s58, 524288
    s_add_u32 s61, s58, 786432
    buffer_load_ushort v100, v116, s[12:15], s55 offen offset:0
    buffer_load_ushort v108, v116, s[16:19], s55 offen offset:0
    buffer_load_ushort v104, v116, s[12:15], s55 offen offset:32
    buffer_load_ushort v112, v116, s[16:19], s55 offen offset:32
    s_add_u32 s55, s55, 131584
    buffer_load_ushort v101, v116, s[12:15], s55 offen offset:0
    buffer_load_ushort v109, v116, s[16:19], s55 offen offset:0
    buffer_load_ushort v105, v116, s[12:15], s55 offen offset:32
    buffer_load_ushort v113, v116, s[16:19], s55 offen offset:32
    s_add_u32 s55, s55, 131584
    buffer_load_ushort v102, v116, s[12:15], s55 offen offset:0
    buffer_load_ushort v110, v116, s[16:19], s55 offen offset:0
    buffer_load_ushort v106, v116, s[12:15], s55 offen offset:32
    buffer_load_ushort v114, v116, s[16:19], s55 offen offset:32
    s_add_u32 s55, s55, 131584
    buffer_load_ushort v103, v116, s[12:15], s55 offen offset:0
    buffer_load_ushort v111, v116, s[16:19], s55 offen offset:0
    buffer_load_ushort v107, v116, s[12:15], s55 offen offset:32
    buffer_load_ushort v115, v116, s[16:19], s55 offen offset:32
    s_mov_b64 exec, 63
    buffer_load_ushort v120, v122, s[12:15], 0 offen
    buffer_load_ushort v121, v122, s[16:19], 0 offen
    s_mov_b64 exec, -1
    s_mov_b32 s55, 6815744
    s_waitcnt vmcnt(18)
    v_pk_add_f32 v[24:25], v[8:9], v[10:11]
    v_pk_add_f32 v[26:27], v[12:13], v[14:15]
    v_pk_mul_f32 v[28:29], v[8:9], v[8:9]
    v_pk_mul_f32 v[30:31], v[10:11], v[10:11]
    v_pk_add_f32 v[24:25], v[24:25], v[16:17]
    v_pk_add_f32 v[26:27], v[26:27], v[18:19]
    v_pk_fma_f32 v[28:29], v[12:13], v[12:13], v[28:29]
    v_pk_fma_f32 v[30:31], v[14:15], v[14:15], v[30:31]
    v_pk_fma_f32 v[28:29], v[16:17], v[16:17], v[28:29]
    v_pk_fma_f32 v[30:31], v[18:19], v[18:19], v[30:31]
    v_pk_fma_f32 v[28:29], v[20:21], v[20:21], v[28:29]
    v_pk_fma_f32 v[30:31], v[22:23], v[22:23], v[30:31]
    v_pk_add_f32 v[24:25], v[24:25], v[20:21]
    v_pk_add_f32 v[26:27], v[26:27], v[22:23]
    v_pk_add_f32 v[28:29], v[28:29], v[30:31]
    v_pk_add_f32 v[24:25], v[24:25], v[26:27]
    s_nop 0
    v_permlane32_swap_b32 v28, v29
    v_permlane32_swap_b32 v24, v25
    v_add_f32 v28, v28, v29
    v_add_f32 v24, v24, v25
    s_nop 1
    v_permlane16_swap_b32 v24, v28
    v_add_f32 v24, v24, v28
    s_nop 1
    v_add_f32_dpp v24, v24, v24 row_ror:8 row_mask:0xf bank_mask:0xf
    s_nop 1
    v_add_f32_dpp v24, v24, v24 row_ror:4 row_mask:0xf bank_mask:0xf
    s_nop 1
    v_add_f32_dpp v24, v24, v24 row_ror:2 row_mask:0xf bank_mask:0xf
    s_nop 1
    v_add_f32_dpp v24, v24, v24 row_ror:1 row_mask:0xf bank_mask:0xf
    v_mul_f32 v24, 0x3b000000, v24
    v_mov_b32 v28, v24
    s_nop 1
    v_permlane16_swap_b32 v24, v28
    v_fma_f32 v28, -v24, v24, v28
    v_cvt_pk_bf16_f32 v4, 0, -v24
    v_cvt_pk_bf16_f32 v28, 0, v28
    v_mov_b32 v5, v4
    v_add_f32 v28, 0x3727c5ac, v28
    v_cvt_pk_bf16_f32 v28, 0, v28
    v_permlane32_swap_b32 v4, v5
    v_sqrt_f32 v28, v28
    v_pk_add_f32 v[8:9], v[8:9], v[4:5]
    v_pk_add_f32 v[10:11], v[10:11], v[4:5]
    v_pk_add_f32 v[12:13], v[12:13], v[4:5]
    v_pk_add_f32 v[14:15], v[14:15], v[4:5]
    v_pk_add_f32 v[16:17], v[16:17], v[4:5]
    v_pk_add_f32 v[18:19], v[18:19], v[4:5]
    v_pk_add_f32 v[20:21], v[20:21], v[4:5]
    v_pk_add_f32 v[22:23], v[22:23], v[4:5]
    v_cvt_pk_bf16_f32 v28, 0, v28
    v_rcp_f32 v6, v28
    v_cvt_pk_bf16_f32 v8, 0, v8
    v_cvt_pk_bf16_f32 v9, 0, v9
    v_cvt_pk_bf16_f32 v10, 0, v10
    v_cvt_pk_bf16_f32 v11, 0, v11
    v_cvt_pk_bf16_f32 v12, 0, v12
    v_cvt_pk_bf16_f32 v13, 0, v13
    v_cvt_pk_bf16_f32 v14, 0, v14
    v_cvt_pk_bf16_f32 v15, 0, v15
    v_cvt_pk_bf16_f32 v16, 0, v16
    v_cvt_pk_bf16_f32 v17, 0, v17
    v_cvt_pk_bf16_f32 v18, 0, v18
    v_cvt_pk_bf16_f32 v19, 0, v19
    v_cvt_pk_bf16_f32 v20, 0, v20
    v_cvt_pk_bf16_f32 v21, 0, v21
    v_cvt_pk_bf16_f32 v22, 0, v22
    v_cvt_pk_bf16_f32 v23, 0, v23
    v_mov_b32 v7, v6
    s_nop 1
    v_permlane32_swap_b32 v6, v7
    v_pk_mul_f32 v[8:9], v[8:9], v[6:7]
    v_pk_mul_f32 v[10:11], v[10:11], v[6:7]
    v_pk_mul_f32 v[12:13], v[12:13], v[6:7]
    v_pk_mul_f32 v[14:15], v[14:15], v[6:7]
    v_pk_mul_f32 v[16:17], v[16:17], v[6:7]
    v_pk_mul_f32 v[18:19], v[18:19], v[6:7]
    v_pk_mul_f32 v[20:21], v[20:21], v[6:7]
    v_pk_mul_f32 v[22:23], v[22:23], v[6:7]
    v_cvt_pk_bf16_f32 v8, 0, v8
    v_cvt_pk_bf16_f32 v9, 0, v9
    v_cvt_pk_bf16_f32 v10, 0, v10
    v_cvt_pk_bf16_f32 v11, 0, v11
    v_cvt_pk_bf16_f32 v12, 0, v12
    v_cvt_pk_bf16_f32 v13, 0, v13
    v_cvt_pk_bf16_f32 v14, 0, v14
    v_cvt_pk_bf16_f32 v15, 0, v15
    v_cvt_pk_bf16_f32 v16, 0, v16
    v_cvt_pk_bf16_f32 v17, 0, v17
    v_cvt_pk_bf16_f32 v18, 0, v18
    v_cvt_pk_bf16_f32 v19, 0, v19
    v_cvt_pk_bf16_f32 v20, 0, v20
    v_cvt_pk_bf16_f32 v21, 0, v21
    v_cvt_pk_bf16_f32 v22, 0, v22
    v_cvt_pk_bf16_f32 v23, 0, v23
    s_waitcnt vmcnt(0)
    v_lshl_or_b32 v100, v108, 16, v100
    v_lshl_or_b32 v101, v109, 16, v101
    v_lshl_or_b32 v102, v110, 16, v102
    v_lshl_or_b32 v103, v111, 16, v103
    v_lshl_or_b32 v104, v112, 16, v104
    v_lshl_or_b32 v105, v113, 16, v105
    v_lshl_or_b32 v106, v114, 16, v106
    v_lshl_or_b32 v107, v115, 16, v107
    v_lshl_or_b32 v120, v121, 16, v120
    buffer_store_dwordx4 v[100:103], v117, s[4:7], s56 offen sc1
    buffer_store_dwordx4 v[104:107], v117, s[4:7], s57 offen sc1
    s_mov_b64 exec, 63
    buffer_store_dword v120, v123, s[4:7], s55 offen sc1
    s_mov_b64 exec, -1
    buffer_load_dword v97, v3, s[20:23], 0 offen sc1
    s_setprio 3
    v_pk_add_f32 v[30:31], v[8:9], v[16:17] neg_lo:[0,1] neg_hi:[0,1]
    v_pk_add_f32 v[8:9], v[8:9], v[16:17]
    v_pk_add_f32 v[16:17], v[10:11], v[18:19] neg_lo:[0,1] neg_hi:[0,1]
    v_pk_add_f32 v[10:11], v[10:11], v[18:19]
    v_pk_add_f32 v[18:19], v[12:13], v[20:21] neg_lo:[0,1] neg_hi:[0,1]
    v_pk_add_f32 v[12:13], v[12:13], v[20:21]
    v_pk_add_f32 v[20:21], v[14:15], v[22:23] neg_lo:[0,1] neg_hi:[0,1]
    v_pk_add_f32 v[14:15], v[14:15], v[22:23]
    v_pk_add_f32 v[22:23], v[16:17], v[16:17] op_sel:[1,0] op_sel_hi:[0,1] neg_hi:[1,0]
    v_pk_add_f32 v[28:29], v[20:21], v[20:21] op_sel:[1,0] op_sel_hi:[0,1] neg_hi:[1,0]
    v_pk_add_f32 v[26:27], v[8:9], v[12:13] neg_lo:[0,1] neg_hi:[0,1]
    v_pk_add_f32 v[8:9], v[8:9], v[12:13]
    v_pk_add_f32 v[12:13], v[10:11], v[14:15] neg_lo:[0,1] neg_hi:[0,1]
    v_pk_add_f32 v[10:11], v[10:11], v[14:15]
    v_pk_add_f32 v[14:15], v[18:19], v[30:31] op_sel:[1,0] op_sel_hi:[0,1] neg_lo:[1,0]
    v_pk_add_f32 v[30:31], v[18:19], v[30:31] op_sel:[1,0] op_sel_hi:[0,1] neg_hi:[1,0]
    v_pk_add_f32 v[18:19], v[28:29], v[22:23] op_sel:[1,0] op_sel_hi:[0,1] neg_lo:[1,0]
    v_pk_add_f32 v[22:23], v[28:29], v[22:23] op_sel:[1,0] op_sel_hi:[0,1] neg_hi:[1,0]
    v_pk_add_f32 v[28:29], v[8:9], v[10:11] neg_lo:[0,1] neg_hi:[0,1]
    v_pk_add_f32 v[8:9], v[8:9], v[10:11]
    v_pk_add_f32 v[10:11], v[12:13], v[26:27] op_sel:[1,0] op_sel_hi:[0,1] neg_lo:[1,0]
    v_pk_add_f32 v[26:27], v[12:13], v[26:27] op_sel:[1,0] op_sel_hi:[0,1] neg_hi:[1,0]
    v_pk_fma_f32 v[12:13], v[22:23], s[26:27], v[30:31] neg_lo:[1,0,0] neg_hi:[1,0,0]
    v_pk_fma_f32 v[30:31], v[22:23], s[26:27], v[30:31]
    v_pk_fma_f32 v[22:23], v[18:19], s[26:27], v[14:15] op_sel:[1,0,0] op_sel_hi:[0,1,1] neg_lo:[1,0,0]
    v_pk_fma_f32 v[14:15], v[18:19], s[26:27], v[14:15] op_sel:[1,0,0] op_sel_hi:[0,1,1] neg_hi:[1,0,0]
    ds_write_b64 v84, v[8:9]
    v_pk_mul_f32 v[16:17], v[30:31], v[32:33] op_sel:[0,0] op_sel_hi:[1,0]
    v_pk_fma_f32 v[30:31], v[30:31], v[32:33], v[16:17] op_sel:[1,1,0] op_sel_hi:[0,1,1] neg_lo:[1,0,0]
    ds_write_b64 v84, v[30:31] offset:8
    v_pk_mul_f32 v[20:21], v[26:27], v[34:35] op_sel:[0,0] op_sel_hi:[1,0]
    v_pk_fma_f32 v[26:27], v[26:27], v[34:35], v[20:21] op_sel:[1,1,0] op_sel_hi:[0,1,1] neg_lo:[1,0,0]
    ds_write_b64 v84, v[26:27] offset:16
    v_pk_mul_f32 v[16:17], v[14:15], v[36:37] op_sel:[0,0] op_sel_hi:[1,0]
    v_pk_fma_f32 v[14:15], v[14:15], v[36:37], v[16:17] op_sel:[1,1,0] op_sel_hi:[0,1,1] neg_lo:[1,0,0]
    ds_write_b64 v84, v[14:15] offset:24
    v_pk_mul_f32 v[20:21], v[28:29], v[38:39] op_sel:[0,0] op_sel_hi:[1,0]
    v_pk_fma_f32 v[28:29], v[28:29], v[38:39], v[20:21] op_sel:[1,1,0] op_sel_hi:[0,1,1] neg_lo:[1,0,0]
    ds_write_b64 v84, v[28:29] offset:32
    v_pk_mul_f32 v[16:17], v[12:13], v[40:41] op_sel:[0,0] op_sel_hi:[1,0]
    v_pk_fma_f32 v[12:13], v[12:13], v[40:41], v[16:17] op_sel:[1,1,0] op_sel_hi:[0,1,1] neg_lo:[1,0,0]
    ds_write_b64 v84, v[12:13] offset:40
    v_pk_mul_f32 v[20:21], v[10:11], v[42:43] op_sel:[0,0] op_sel_hi:[1,0]
    v_pk_fma_f32 v[10:11], v[10:11], v[42:43], v[20:21] op_sel:[1,1,0] op_sel_hi:[0,1,1] neg_lo:[1,0,0]
    ds_write_b64 v84, v[10:11] offset:48
    v_pk_mul_f32 v[16:17], v[22:23], v[44:45] op_sel:[0,0] op_sel_hi:[1,0]
    v_pk_fma_f32 v[22:23], v[22:23], v[44:45], v[16:17] op_sel:[1,1,0] op_sel_hi:[0,1,1] neg_lo:[1,0,0]
    ds_write_b64 v84, v[22:23] offset:56
    ds_read_b64 v[8:9], v85 offset:0
    ds_read_b64 v[30:31], v85 offset:576
    ds_read_b64 v[26:27], v85 offset:1152
    ds_read_b64 v[14:15], v85 offset:1728
    ds_read_b64 v[28:29], v85 offset:2304
    ds_read_b64 v[12:13], v85 offset:2880
    ds_read_b64 v[10:11], v85 offset:3456
    ds_read_b64 v[22:23], v85 offset:4032
    s_waitcnt lgkmcnt(0)
    v_pk_add_f32 v[18:19], v[8:9], v[28:29] neg_lo:[0,1] neg_hi:[0,1]
    v_pk_add_f32 v[8:9], v[8:9], v[28:29]
    v_pk_add_f32 v[28:29], v[30:31], v[12:13] neg_lo:[0,1] neg_hi:[0,1]
    v_pk_add_f32 v[30:31], v[30:31], v[12:13]
    v_pk_add_f32 v[12:13], v[26:27], v[10:11] neg_lo:[0,1] neg_hi:[0,1]
    v_pk_add_f32 v[26:27], v[26:27], v[10:11]
    v_pk_add_f32 v[10:11], v[14:15], v[22:23] neg_lo:[0,1] neg_hi:[0,1]
    v_pk_add_f32 v[14:15], v[14:15], v[22:23]
    v_pk_add_f32 v[22:23], v[28:29], v[28:29] op_sel:[1,0] op_sel_hi:[0,1] neg_hi:[1,0]
    v_pk_add_f32 v[24:25], v[10:11], v[10:11] op_sel:[1,0] op_sel_hi:[0,1] neg_hi:[1,0]
    v_pk_add_f32 v[16:17], v[8:9], v[26:27] neg_lo:[0,1] neg_hi:[0,1]
    v_pk_add_f32 v[8:9], v[8:9], v[26:27]
    v_pk_add_f32 v[26:27], v[30:31], v[14:15] neg_lo:[0,1] neg_hi:[0,1]
    v_pk_add_f32 v[30:31], v[30:31], v[14:15]
    v_pk_add_f32 v[14:15], v[12:13], v[18:19] op_sel:[1,0] op_sel_hi:[0,1] neg_lo:[1,0]
    v_pk_add_f32 v[18:19], v[12:13], v[18:19] op_sel:[1,0] op_sel_hi:[0,1] neg_hi:[1,0]
    v_pk_add_f32 v[12:13], v[24:25], v[22:23] op_sel:[1,0] op_sel_hi:[0,1] neg_lo:[1,0]
    v_pk_add_f32 v[22:23], v[24:25], v[22:23] op_sel:[1,0] op_sel_hi:[0,1] neg_hi:[1,0]
    v_pk_add_f32 v[24:25], v[8:9], v[30:31] neg_lo:[0,1] neg_hi:[0,1]
    v_pk_add_f32 v[8:9], v[8:9], v[30:31]
    v_pk_add_f32 v[30:31], v[26:27], v[16:17] op_sel:[1,0] op_sel_hi:[0,1] neg_lo:[1,0]
    v_pk_add_f32 v[16:17], v[26:27], v[16:17] op_sel:[1,0] op_sel_hi:[0,1] neg_hi:[1,0]
    v_pk_fma_f32 v[26:27], v[22:23], s[26:27], v[18:19] neg_lo:[1,0,0] neg_hi:[1,0,0]
    v_pk_fma_f32 v[18:19], v[22:23], s[26:27], v[18:19]
    v_pk_fma_f32 v[22:23], v[12:13], s[26:27], v[14:15] op_sel:[1,0,0] op_sel_hi:[0,1,1] neg_lo:[1,0,0]
    v_pk_fma_f32 v[14:15], v[12:13], s[26:27], v[14:15] op_sel:[1,0,0] op_sel_hi:[0,1,1] neg_hi:[1,0,0]
    v_pk_mul_f32 v[10:11], v[8:9], v[46:47] op_sel:[0,0] op_sel_hi:[1,0]
    v_pk_fma_f32 v[8:9], v[8:9], v[46:47], v[10:11] op_sel:[1,1,0] op_sel_hi:[0,1,1] neg_lo:[1,0,0]
    ds_write_b64 v86, v[8:9] offset:0
    v_pk_mul_f32 v[28:29], v[18:19], v[48:49] op_sel:[0,0] op_sel_hi:[1,0]
    v_pk_fma_f32 v[18:19], v[18:19], v[48:49], v[28:29] op_sel:[1,1,0] op_sel_hi:[0,1,1] neg_lo:[1,0,0]
    ds_write_b64 v86, v[18:19] offset:64
    v_pk_mul_f32 v[10:11], v[16:17], v[50:51] op_sel:[0,0] op_sel_hi:[1,0]
    v_pk_fma_f32 v[16:17], v[16:17], v[50:51], v[10:11] op_sel:[1,1,0] op_sel_hi:[0,1,1] neg_lo:[1,0,0]
    ds_write_b64 v86, v[16:17] offset:128
    v_pk_mul_f32 v[28:29], v[14:15], v[52:53] op_sel:[0,0] op_sel_hi:[1,0]
    v_pk_fma_f32 v[14:15], v[14:15], v[52:53], v[28:29] op_sel:[1,1,0] op_sel_hi:[0,1,1] neg_lo:[1,0,0]
    ds_write_b64 v86, v[14:15] offset:192
    v_pk_mul_f32 v[10:11], v[24:25], v[54:55] op_sel:[0,0] op_sel_hi:[1,0]
    v_pk_fma_f32 v[24:25], v[24:25], v[54:55], v[10:11] op_sel:[1,1,0] op_sel_hi:[0,1,1] neg_lo:[1,0,0]
    ds_write_b64 v86, v[24:25] offset:256
    v_pk_mul_f32 v[28:29], v[26:27], v[56:57] op_sel:[0,0] op_sel_hi:[1,0]
    v_pk_fma_f32 v[26:27], v[26:27], v[56:57], v[28:29] op_sel:[1,1,0] op_sel_hi:[0,1,1] neg_lo:[1,0,0]
    ds_write_b64 v86, v[26:27] offset:320
    v_pk_mul_f32 v[10:11], v[30:31], v[58:59] op_sel:[0,0] op_sel_hi:[1,0]
    v_pk_fma_f32 v[30:31], v[30:31], v[58:59], v[10:11] op_sel:[1,1,0] op_sel_hi:[0,1,1] neg_lo:[1,0,0]
    ds_write_b64 v86, v[30:31] offset:384
    v_pk_mul_f32 v[28:29], v[22:23], v[60:61] op_sel:[0,0] op_sel_hi:[1,0]
    v_pk_fma_f32 v[22:23], v[22:23], v[60:61], v[28:29] op_sel:[1,1,0] op_sel_hi:[0,1,1] neg_lo:[1,0,0]
    ds_write_b64 v86, v[22:23] offset:448
    ds_read_b64 v[8:9], v87 offset:0
    ds_read_b64 v[18:19], v87 offset:576
    ds_read_b64 v[16:17], v87 offset:1152
    ds_read_b64 v[14:15], v87 offset:1728
    ds_read_b64 v[24:25], v87 offset:2304
    ds_read_b64 v[26:27], v87 offset:2880
    ds_read_b64 v[30:31], v87 offset:3456
    ds_read_b64 v[22:23], v87 offset:4032
    s_waitcnt lgkmcnt(0)
    v_pk_add_f32 v[12:13], v[8:9], v[24:25] neg_lo:[0,1] neg_hi:[0,1]
    v_pk_add_f32 v[8:9], v[8:9], v[24:25]
    v_pk_add_f32 v[24:25], v[18:19], v[26:27] neg_lo:[0,1] neg_hi:[0,1]
    v_pk_add_f32 v[18:19], v[18:19], v[26:27]
    v_pk_add_f32 v[26:27], v[16:17], v[30:31] neg_lo:[0,1] neg_hi:[0,1]
    v_pk_add_f32 v[16:17], v[16:17], v[30:31]
    v_pk_add_f32 v[30:31], v[14:15], v[22:23] neg_lo:[0,1] neg_hi:[0,1]
    v_pk_add_f32 v[14:15], v[14:15], v[22:23]
    v_pk_add_f32 v[22:23], v[24:25], v[24:25] op_sel:[1,0] op_sel_hi:[0,1] neg_hi:[1,0]
    v_pk_add_f32 v[20:21], v[30:31], v[30:31] op_sel:[1,0] op_sel_hi:[0,1] neg_hi:[1,0]
    v_pk_add_f32 v[28:29], v[8:9], v[16:17] neg_lo:[0,1] neg_hi:[0,1]
    v_pk_add_f32 v[8:9], v[8:9], v[16:17]
    v_pk_add_f32 v[16:17], v[18:19], v[14:15] neg_lo:[0,1] neg_hi:[0,1]
    v_pk_add_f32 v[18:19], v[18:19], v[14:15]
    v_pk_add_f32 v[14:15], v[26:27], v[12:13] op_sel:[1,0] op_sel_hi:[0,1] neg_lo:[1,0]
    v_pk_add_f32 v[12:13], v[26:27], v[12:13] op_sel:[1,0] op_sel_hi:[0,1] neg_hi:[1,0]
    v_pk_add_f32 v[26:27], v[20:21], v[22:23] op_sel:[1,0] op_sel_hi:[0,1] neg_lo:[1,0]
    v_pk_add_f32 v[22:23], v[20:21], v[22:23] op_sel:[1,0] op_sel_hi:[0,1] neg_hi:[1,0]
    v_pk_add_f32 v[20:21], v[8:9], v[18:19] neg_lo:[0,1] neg_hi:[0,1]
    v_pk_add_f32 v[8:9], v[8:9], v[18:19]
    v_pk_add_f32 v[18:19], v[16:17], v[28:29] op_sel:[1,0] op_sel_hi:[0,1] neg_lo:[1,0]
    v_pk_add_f32 v[28:29], v[16:17], v[28:29] op_sel:[1,0] op_sel_hi:[0,1] neg_hi:[1,0]
    v_pk_fma_f32 v[16:17], v[22:23], s[26:27], v[12:13] neg_lo:[1,0,0] neg_hi:[1,0,0]
    v_pk_fma_f32 v[12:13], v[22:23], s[26:27], v[12:13]
    v_pk_fma_f32 v[22:23], v[26:27], s[26:27], v[14:15] op_sel:[1,0,0] op_sel_hi:[0,1,1] neg_lo:[1,0,0]
    v_pk_fma_f32 v[14:15], v[26:27], s[26:27], v[14:15] op_sel:[1,0,0] op_sel_hi:[0,1,1] neg_hi:[1,0,0]
    ds_write_b64 v87, v[20:21] offset:2048
    ds_write_b64 v87, v[16:17] offset:2560
    ds_write_b64 v87, v[18:19] offset:3072
    ds_write_b64 v87, v[22:23] offset:3584
    ds_write_b64 v87, v[8:9] offset:4096
    ds_read_b64 v[128:129], v88 offset:1536
    ds_read_b64 v[130:131], v88 offset:1024
    ds_read_b64 v[132:133], v88 offset:512
    ds_read_b64 v[134:135], v88 offset:0
    v_add_f32 v124, v20, v20
    v_add_f32 v125, v21, v21
    v_cmp_eq_u32 vcc, 0, v1
    s_waitcnt lgkmcnt(3)
    v_pk_add_f32 v[108:109], v[8:9], v[128:129] neg_hi:[0,1]
    v_pk_add_f32 v[110:111], v[8:9], v[128:129] op_sel:[1,1] op_sel_hi:[0,0] neg_hi:[1,0]
    v_cndmask_b32 v109, v109, v124, vcc
    v_cndmask_b32 v111, v111, v125, vcc
    ds_write_b128 v89, v[108:111] offset:0
    s_waitcnt lgkmcnt(3)
    v_pk_add_f32 v[112:113], v[12:13], v[130:131] neg_hi:[0,1]
    v_pk_add_f32 v[114:115], v[12:13], v[130:131] op_sel:[1,1] op_sel_hi:[0,0] neg_hi:[1,0]
    ds_write_b128 v89, v[112:115] offset:4096
    s_waitcnt lgkmcnt(3)
    v_pk_add_f32 v[116:117], v[28:29], v[132:133] neg_hi:[0,1]
    v_pk_add_f32 v[118:119], v[28:29], v[132:133] op_sel:[1,1] op_sel_hi:[0,0] neg_hi:[1,0]
    ds_write_b128 v89, v[116:119] offset:8192
    s_waitcnt lgkmcnt(3)
    v_pk_add_f32 v[120:121], v[14:15], v[134:135] neg_hi:[0,1]
    v_pk_add_f32 v[122:123], v[14:15], v[134:135] op_sel:[1,1] op_sel_hi:[0,0] neg_hi:[1,0]
    ds_write_b128 v89, v[120:123] offset:12288
    s_waitcnt vmcnt(0)
    v_cmp_eq_u32 vcc, 0, v97
    s_nop 4
    s_cmp_eq_u64 vcc, 0
    s_cbranch_scc1 M_Z1_X
    s_mov_b32 s52, 0
M_Z1_L:
    buffer_load_dword v97, v3, s[20:23], 0 offen sc1
    s_waitcnt vmcnt(0)
    v_cmp_eq_u32 vcc, 0, v97
    s_add_u32 s52, s52, 1
    s_cmp_ge_u32 s52, 100000
    s_cbranch_scc1 M_Z1_X
    s_nop 3
    s_cmp_eq_u64 vcc, 0
    s_cbranch_scc1 M_Z1_X
    s_sleep 2
    s_branch M_Z1_L
M_Z1_X:
    ds_write_b32 v98, v97 offset:28
    v_mov_b32 v99, 1
    s_mov_b64 exec, 1
    ds_add_rtn_u32 v99, v98, v99 offset:0
    s_mov_b64 exec, -1
    s_waitcnt lgkmcnt(0)
    v_readfirstlane_b32 s52, v99
    s_cmp_eq_u32 s52, 3
    s_mov_b32 s53, 0x01010101
    v_and_b32 v4, 3, v1
    v_lshlrev_b32 v4, 3, v4
    v_lshrrev_b32 v136, v4, v97
    v_lshrrev_b32 v4, 4, v1
    v_xor_b32 v4, v4, v1
    v_and_b32 v4, 3, v4
    v_lshlrev_b32 v4, 3, v4
    v_lshrrev_b32 v141, v4, v97
    v_lshrrev_b32 v137, 2, v136
    v_lshrrev_b32 v138, 4, v136
    v_lshrrev_b32 v139, 6, v136
    v_and_b32 v140, 255, v136
    v_and_b32 v141, 255, v141
    v_mul_lo_u32 v140, v140, s53
    v_mul_lo_u32 v141, v141, s53
    s_cbranch_scc1 M_B1_X
    s_mov_b32 s52, 0
M_B1_L:
    ds_read_b32 v99, v98 offset:0
    s_add_u32 s52, s52, 1
    s_cmp_ge_u32 s52, 400000
    s_cbranch_scc1 M_B1_X
    s_waitcnt lgkmcnt(0)
    v_cmp_gt_u32 vcc, 4, v99
    s_cbranch_vccnz M_B1_L
M_B1_X:
    ds_read_b128 v[8:11], v90 offset:0
    ds_read_b128 v[12:15], v90 offset:1024
    ds_read_b128 v[16:19], v90 offset:2048
    ds_read_b128 v[20:23], v90 offset:3072
    s_waitcnt lgkmcnt(3)
    v_bfi_b32 v8, 3, v136, v8
    v_bfi_b32 v9, 3, v137, v9
    v_bfi_b32 v10, 3, v138, v10
    v_bfi_b32 v11, 3, v139, v11
    buffer_store_dwordx4 v[8:11], v91, s[4:7], s58 offen sc1
    s_waitcnt lgkmcnt(2)
    v_bfi_b32 v12, 3, v136, v12
    v_bfi_b32 v13, 3, v137, v13
    v_bfi_b32 v14, 3, v138, v14
    v_bfi_b32 v15, 3, v139, v15
    buffer_store_dwordx4 v[12:15], v91, s[4:7], s59 offen sc1
    s_waitcnt lgkmcnt(1)
    v_bfi_b32 v16, 3, v136, v16
    v_bfi_b32 v17, 3, v137, v17
    v_bfi_b32 v18, 3, v138, v18
    v_bfi_b32 v19, 3, v139, v19
    buffer_store_dwordx4 v[16:19], v91, s[4:7], s60 offen sc1
    s_waitcnt lgkmcnt(0)
    v_bfi_b32 v20, 3, v136, v20
    v_bfi_b32 v21, 3, v137, v21
    v_bfi_b32 v22, 3, v138, v22
    v_bfi_b32 v23, 3, v139, v23
    buffer_store_dwordx4 v[20:23], v91, s[4:7], s61 offen sc1
    s_lshl_b32 s54, s29, 14
    s_add_u32 s58, s54, 7340032
    s_add_u32 s55, s54, 4096
    s_add_u32 s56, s54, 8192
    s_add_u32 s57, s54, 12288
    s_add_u32 s59, s58, 4096
    s_add_u32 s60, s58, 8192
    s_add_u32 s61, s58, 12288
    s_lshl_b32 s62, s29, 13
    s_lshl_b32 s53, s24, 11
    s_add_u32 s62, s62, s53
    s_add_u32 s62, s62, 4718592
    v_lshlrev_b32 v92, 4, v0
    v_add_u32 v94, s3, v92
    v_lshlrev_b32 v93, 4, v1
    s_waitcnt vmcnt(0) lgkmcnt(0)
M_P2POLL:
    s_setprio 3
    s_mov_b32 s52, 0
M_P2P_L:
    buffer_load_dwordx4 v[8:11], v92, s[4:7], s54 offen sc1
    buffer_load_dwordx4 v[12:15], v92, s[4:7], s55 offen sc1
    buffer_load_dwordx4 v[16:19], v92, s[4:7], s56 offen sc1
    buffer_load_dwordx4 v[20:23], v92, s[4:7], s57 offen sc1
    s_waitcnt vmcnt(3)
    v_alignbit_b32 v6, v8, v6, 2
    v_and_b32 v8, -4, v8
    v_alignbit_b32 v6, v9, v6, 2
    v_and_b32 v9, -4, v9
    v_alignbit_b32 v6, v10, v6, 2
    v_and_b32 v10, -4, v10
    v_alignbit_b32 v6, v11, v6, 2
    v_and_b32 v11, -4, v11
    s_waitcnt vmcnt(2)
    v_alignbit_b32 v6, v12, v6, 2
    v_and_b32 v12, -4, v12
    v_alignbit_b32 v6, v13, v6, 2
    v_and_b32 v13, -4, v13
    v_alignbit_b32 v6, v14, v6, 2
    v_and_b32 v14, -4, v14
    v_alignbit_b32 v6, v15, v6, 2
    v_and_b32 v15, -4, v15
    s_waitcnt vmcnt(1)
    v_alignbit_b32 v6, v16, v6, 2
    v_and_b32 v16, -4, v16
    v_alignbit_b32 v6, v17, v6, 2
    v_and_b32 v17, -4, v17
    v_alignbit_b32 v6, v18, v6, 2
    v_and_b32 v18, -4, v18
    v_alignbit_b32 v6, v19, v6, 2
    v_and_b32 v19, -4, v19
    s_waitcnt vmcnt(0)
    v_alignbit_b32 v6, v20, v6, 2
    v_and_b32 v20, -4, v20
    v_alignbit_b32 v6, v21, v6, 2
    v_and_b32 v21, -4, v21
    v_alignbit_b32 v6, v22, v6, 2
    v_and_b32 v22, -4, v22
    v_alignbit_b32 v6, v23, v6, 2
    v_and_b32 v23, -4, v23
    v_xor_b32 v6, v140, v6
    s_nop 1
    v_or_b32_dpp v6, v6, v6 quad_perm:[1,0,3,2] row_mask:0xf bank_mask:0xf
    s_nop 1
    v_or_b32_dpp v6, v6, v6 quad_perm:[2,3,0,1] row_mask:0xf bank_mask:0xf
    v_cmp_ne_u32 vcc, 0, v6
    s_nop 4
    s_mov_b64 exec, vcc
    s_add_u32 s52, s52, 1
    s_cmp_ge_u32 s52, 100000
    s_cbranch_scc1 M_P2P_X
    s_nop 3
    s_cmp_eq_u64 vcc, 0
    s_cbranch_scc1 M_P2P_X
    s_sleep 1
    s_branch M_P2P_L
M_P2P_X:
    s_mov_b64 exec, -1
    v_pk_add_f32 v[28:29], v[8:9], v[16:17] neg_lo:[0,1] neg_hi:[0,1]
    v_pk_add_f32 v[8:9], v[8:9], v[16:17]
    v_pk_add_f32 v[30:31], v[10:11], v[18:19] neg_lo:[0,1] neg_hi:[0,1]
    v_pk_add_f32 v[10:11], v[10:11], v[18:19]
    v_pk_add_f32 v[16:17], v[12:13], v[20:21] neg_lo:[0,1] neg_hi:[0,1]
    v_pk_add_f32 v[12:13], v[12:13], v[20:21]
    v_pk_add_f32 v[18:19], v[14:15], v[22:23] neg_lo:[0,1] neg_hi:[0,1]
    v_pk_add_f32 v[14:15], v[14:15], v[22:23]
    v_pk_add_f32 v[20:21], v[8:9], v[12:13] neg_lo:[0,1] neg_hi:[0,1]
    v_pk_add_f32 v[8:9], v[8:9], v[12:13]
    v_pk_add_f32 v[22:23], v[10:11], v[14:15] neg_lo:[0,1] neg_hi:[0,1]
    v_pk_add_f32 v[10:11], v[10:11], v[14:15]
    v_pk_add_f32 v[12:13], v[16:17], v[28:29] op_sel:[1,0] op_sel_hi:[0,1] neg_lo:[1,0]
    v_pk_add_f32 v[28:29], v[16:17], v[28:29] op_sel:[1,0] op_sel_hi:[0,1] neg_hi:[1,0]
    v_pk_add_f32 v[14:15], v[18:19], v[30:31] op_sel:[1,0] op_sel_hi:[0,1] neg_lo:[1,0]
    v_pk_add_f32 v[30:31], v[18:19], v[30:31] op_sel:[1,0] op_sel_hi:[0,1] neg_hi:[1,0]
    ds_write_b128 v94, v[8:11] offset:0
    v_pk_mul_f32 v[88:89], v[28:29], v[148:149] op_sel:[0,0] op_sel_hi:[1,0]
    v_pk_fma_f32 v[28:29], v[28:29], v[148:149], v[88:89] op_sel:[1,1,0] op_sel_hi:[0,1,1] neg_lo:[1,0,0]
    v_pk_mul_f32 v[90:91], v[30:31], v[150:151] op_sel:[0,0] op_sel_hi:[1,0]
    v_pk_fma_f32 v[30:31], v[30:31], v[150:151], v[90:91] op_sel:[1,1,0] op_sel_hi:[0,1,1] neg_lo:[1,0,0]
    ds_write_b128 v94, v[28:31] offset:4608
    v_pk_mul_f32 v[88:89], v[20:21], v[152:153] op_sel:[0,0] op_sel_hi:[1,0]
    v_pk_fma_f32 v[20:21], v[20:21], v[152:153], v[88:89] op_sel:[1,1,0] op_sel_hi:[0,1,1] neg_lo:[1,0,0]
    v_pk_mul_f32 v[90:91], v[22:23], v[154:155] op_sel:[0,0] op_sel_hi:[1,0]
    v_pk_fma_f32 v[22:23], v[22:23], v[154:155], v[90:91] op_sel:[1,1,0] op_sel_hi:[0,1,1] neg_lo:[1,0,0]
    ds_write_b128 v94, v[20:23] offset:9216
    v_pk_mul_f32 v[88:89], v[12:13], v[156:157] op_sel:[0,0] op_sel_hi:[1,0]
    v_pk_fma_f32 v[12:13], v[12:13], v[156:157], v[88:89] op_sel:[1,1,0] op_sel_hi:[0,1,1] neg_lo:[1,0,0]
    v_pk_mul_f32 v[90:91], v[14:15], v[158:159] op_sel:[0,0] op_sel_hi:[1,0]
    v_pk_fma_f32 v[14:15], v[14:15], v[158:159], v[90:91] op_sel:[1,1,0] op_sel_hi:[0,1,1] neg_lo:[1,0,0]
    ds_write_b128 v94, v[12:15] offset:13824
    v_mov_b32 v99, 1
    s_mov_b64 exec, 1
    ds_add_rtn_u32 v99, v98, v99 offset:0
    s_mov_b64 exec, -1
    s_waitcnt lgkmcnt(0)
    v_readfirstlane_b32 s52, v99
    s_cmp_eq_u32 s52, 7
    s_cbranch_scc1 M_B4_X
    s_mov_b32 s52, 0
M_B4_L:
    ds_read_b32 v99, v98 offset:0
    s_add_u32 s52, s52, 1
    s_cmp_ge_u32 s52, 400000
    s_cbranch_scc1 M_B4_X
    s_waitcnt lgkmcnt(0)
    v_cmp_gt_u32 vcc, 8, v99
    s_cbranch_vccnz M_B4_L
M_B4_X:
    ds_read_b64 v[8:9], v87 offset:0
    ds_read_b64 v[10:11], v87 offset:512
    ds_read_b64 v[12:13], v87 offset:1024
    ds_read_b64 v[14:15], v87 offset:1536
    ds_read_b64 v[16:17], v87 offset:2048
    ds_read_b64 v[18:19], v87 offset:2560
    ds_read_b64 v[20:21], v87 offset:3072
    ds_read_b64 v[22:23], v87 offset:3584
    buffer_load_dwordx4 v[64:67], v93, s[4:7], s62 offen offset:0 sc1
    buffer_load_dwordx4 v[68:71], v93, s[4:7], s62 offen offset:1024 sc1
    s_mov_b32 s52, 0x35000000
    s_mov_b32 s53, 0x35000000
    s_mov_b32 s63, 0xffff0000
    s_waitcnt lgkmcnt(0)
    v_pk_add_f32 v[30:31], v[8:9], v[16:17] neg_lo:[0,1] neg_hi:[0,1]
    v_pk_add_f32 v[8:9], v[8:9], v[16:17]
    v_pk_add_f32 v[16:17], v[10:11], v[18:19] neg_lo:[0,1] neg_hi:[0,1]
    v_pk_add_f32 v[10:11], v[10:11], v[18:19]
    v_pk_add_f32 v[18:19], v[12:13], v[20:21] neg_lo:[0,1] neg_hi:[0,1]
    v_pk_add_f32 v[12:13], v[12:13], v[20:21]
    v_pk_add_f32 v[20:21], v[14:15], v[22:23] neg_lo:[0,1] neg_hi:[0,1]
    v_pk_add_f32 v[14:15], v[14:15], v[22:23]
    v_pk_add_f32 v[22:23], v[16:17], v[16:17] op_sel:[1,0] op_sel_hi:[0,1] neg_hi:[1,0]
    v_pk_add_f32 v[28:29], v[20:21], v[20:21] op_sel:[1,0] op_sel_hi:[0,1] neg_hi:[1,0]
    v_pk_add_f32 v[26:27], v[8:9], v[12:13] neg_lo:[0,1] neg_hi:[0,1]
    v_pk_add_f32 v[8:9], v[8:9], v[12:13]
    v_pk_add_f32 v[12:13], v[10:11], v[14:15] neg_lo:[0,1] neg_hi:[0,1]
    v_pk_add_f32 v[10:11], v[10:11], v[14:15]
    v_pk_add_f32 v[14:15], v[18:19], v[30:31] op_sel:[1,0] op_sel_hi:[0,1] neg_lo:[1,0]
    v_pk_add_f32 v[30:31], v[18:19], v[30:31] op_sel:[1,0] op_sel_hi:[0,1] neg_hi:[1,0]
    v_pk_add_f32 v[18:19], v[28:29], v[22:23] op_sel:[1,0] op_sel_hi:[0,1] neg_lo:[1,0]
    v_pk_add_f32 v[22:23], v[28:29], v[22:23] op_sel:[1,0] op_sel_hi:[0,1] neg_hi:[1,0]
    v_pk_add_f32 v[28:29], v[8:9], v[10:11] neg_lo:[0,1] neg_hi:[0,1]
    v_pk_add_f32 v[8:9], v[8:9], v[10:11]
    v_pk_add_f32 v[10:11], v[12:13], v[26:27] op_sel:[1,0] op_sel_hi:[0,1] neg_lo:[1,0]
    v_pk_add_f32 v[26:27], v[12:13], v[26:27] op_sel:[1,0] op_sel_hi:[0,1] neg_hi:[1,0]
    v_pk_fma_f32 v[12:13], v[22:23], s[26:27], v[30:31] neg_lo:[1,0,0] neg_hi:[1,0,0]
    v_pk_fma_f32 v[30:31], v[22:23], s[26:27], v[30:31]
    v_pk_fma_f32 v[22:23], v[18:19], s[26:27], v[14:15] op_sel:[1,0,0] op_sel_hi:[0,1,1] neg_lo:[1,0,0]
    v_pk_fma_f32 v[14:15], v[18:19], s[26:27], v[14:15] op_sel:[1,0,0] op_sel_hi:[0,1,1] neg_hi:[1,0,0]
    ds_write_b64 v84, v[8:9]
    v_pk_mul_f32 v[16:17], v[30:31], v[32:33] op_sel:[0,0] op_sel_hi:[1,0]
    v_pk_fma_f32 v[30:31], v[30:31], v[32:33], v[16:17] op_sel:[1,1,0] op_sel_hi:[0,1,1] neg_lo:[1,0,0]
    ds_write_b64 v84, v[30:31] offset:8
    v_pk_mul_f32 v[20:21], v[26:27], v[34:35] op_sel:[0,0] op_sel_hi:[1,0]
    v_pk_fma_f32 v[26:27], v[26:27], v[34:35], v[20:21] op_sel:[1,1,0] op_sel_hi:[0,1,1] neg_lo:[1,0,0]
    ds_write_b64 v84, v[26:27] offset:16
    v_pk_mul_f32 v[16:17], v[14:15], v[36:37] op_sel:[0,0] op_sel_hi:[1,0]
    v_pk_fma_f32 v[14:15], v[14:15], v[36:37], v[16:17] op_sel:[1,1,0] op_sel_hi:[0,1,1] neg_lo:[1,0,0]
    ds_write_b64 v84, v[14:15] offset:24
    v_pk_mul_f32 v[20:21], v[28:29], v[38:39] op_sel:[0,0] op_sel_hi:[1,0]
    v_pk_fma_f32 v[28:29], v[28:29], v[38:39], v[20:21] op_sel:[1,1,0] op_sel_hi:[0,1,1] neg_lo:[1,0,0]
    ds_write_b64 v84, v[28:29] offset:32
    v_pk_mul_f32 v[16:17], v[12:13], v[40:41] op_sel:[0,0] op_sel_hi:[1,0]
    v_pk_fma_f32 v[12:13], v[12:13], v[40:41], v[16:17] op_sel:[1,1,0] op_sel_hi:[0,1,1] neg_lo:[1,0,0]
    ds_write_b64 v84, v[12:13] offset:40
    v_pk_mul_f32 v[20:21], v[10:11], v[42:43] op_sel:[0,0] op_sel_hi:[1,0]
    v_pk_fma_f32 v[10:11], v[10:11], v[42:43], v[20:21] op_sel:[1,1,0] op_sel_hi:[0,1,1] neg_lo:[1,0,0]
    ds_write_b64 v84, v[10:11] offset:48
    v_pk_mul_f32 v[16:17], v[22:23], v[44:45] op_sel:[0,0] op_sel_hi:[1,0]
    v_pk_fma_f32 v[22:23], v[22:23], v[44:45], v[16:17] op_sel:[1,1,0] op_sel_hi:[0,1,1] neg_lo:[1,0,0]
    ds_write_b64 v84, v[22:23] offset:56
    ds_read_b64 v[8:9], v85 offset:0
    ds_read_b64 v[30:31], v85 offset:576
    ds_read_b64 v[26:27], v85 offset:1152
    ds_read_b64 v[14:15], v85 offset:1728
    ds_read_b64 v[28:29], v85 offset:2304
    ds_read_b64 v[12:13], v85 offset:2880
    ds_read_b64 v[10:11], v85 offset:3456
    ds_read_b64 v[22:23], v85 offset:4032
    s_waitcnt lgkmcnt(0)
    v_pk_add_f32 v[18:19], v[8:9], v[28:29] neg_lo:[0,1] neg_hi:[0,1]
    v_pk_add_f32 v[8:9], v[8:9], v[28:29]
    v_pk_add_f32 v[28:29], v[30:31], v[12:13] neg_lo:[0,1] neg_hi:[0,1]
    v_pk_add_f32 v[30:31], v[30:31], v[12:13]
    v_pk_add_f32 v[12:13], v[26:27], v[10:11] neg_lo:[0,1] neg_hi:[0,1]
    v_pk_add_f32 v[26:27], v[26:27], v[10:11]
    v_pk_add_f32 v[10:11], v[14:15], v[22:23] neg_lo:[0,1] neg_hi:[0,1]
    v_pk_add_f32 v[14:15], v[14:15], v[22:23]
    v_pk_add_f32 v[22:23], v[28:29], v[28:29] op_sel:[1,0] op_sel_hi:[0,1] neg_hi:[1,0]
    v_pk_add_f32 v[24:25], v[10:11], v[10:11] op_sel:[1,0] op_sel_hi:[0,1] neg_hi:[1,0]
    v_pk_add_f32 v[16:17], v[8:9], v[26:27] neg_lo:[0,1] neg_hi:[0,1]
    v_pk_add_f32 v[8:9], v[8:9], v[26:27]
    v_pk_add_f32 v[26:27], v[30:31], v[14:15] neg_lo:[0,1] neg_hi:[0,1]
    v_pk_add_f32 v[30:31], v[30:31], v[14:15]
    v_pk_add_f32 v[14:15], v[12:13], v[18:19] op_sel:[1,0] op_sel_hi:[0,1] neg_lo:[1,0]
    v_pk_add_f32 v[18:19], v[12:13], v[18:19] op_sel:[1,0] op_sel_hi:[0,1] neg_hi:[1,0]
    v_pk_add_f32 v[12:13], v[24:25], v[22:23] op_sel:[1,0] op_sel_hi:[0,1] neg_lo:[1,0]
    v_pk_add_f32 v[22:23], v[24:25], v[22:23] op_sel:[1,0] op_sel_hi:[0,1] neg_hi:[1,0]
    v_pk_add_f32 v[24:25], v[8:9], v[30:31] neg_lo:[0,1] neg_hi:[0,1]
    v_pk_add_f32 v[8:9], v[8:9], v[30:31]
    v_pk_add_f32 v[30:31], v[26:27], v[16:17] op_sel:[1,0] op_sel_hi:[0,1] neg_lo:[1,0]
    v_pk_add_f32 v[16:17], v[26:27], v[16:17] op_sel:[1,0] op_sel_hi:[0,1] neg_hi:[1,0]
    v_pk_fma_f32 v[26:27], v[22:23], s[26:27], v[18:19] neg_lo:[1,0,0] neg_hi:[1,0,0]
    v_pk_fma_f32 v[18:19], v[22:23], s[26:27], v[18:19]
    v_pk_fma_f32 v[22:23], v[12:13], s[26:27], v[14:15] op_sel:[1,0,0] op_sel_hi:[0,1,1] neg_lo:[1,0,0]
    v_pk_fma_f32 v[14:15], v[12:13], s[26:27], v[14:15] op_sel:[1,0,0] op_sel_hi:[0,1,1] neg_hi:[1,0,0]
    v_pk_mul_f32 v[10:11], v[8:9], v[46:47] op_sel:[0,0] op_sel_hi:[1,0]
    v_pk_fma_f32 v[8:9], v[8:9], v[46:47], v[10:11] op_sel:[1,1,0] op_sel_hi:[0,1,1] neg_lo:[1,0,0]
    ds_write_b64 v86, v[8:9] offset:0
    v_pk_mul_f32 v[28:29], v[18:19], v[48:49] op_sel:[0,0] op_sel_hi:[1,0]
    v_pk_fma_f32 v[18:19], v[18:19], v[48:49], v[28:29] op_sel:[1,1,0] op_sel_hi:[0,1,1] neg_lo:[1,0,0]
    ds_write_b64 v86, v[18:19] offset:64
    v_pk_mul_f32 v[10:11], v[16:17], v[50:51] op_sel:[0,0] op_sel_hi:[1,0]
    v_pk_fma_f32 v[16:17], v[16:17], v[50:51], v[10:11] op_sel:[1,1,0] op_sel_hi:[0,1,1] neg_lo:[1,0,0]
    ds_write_b64 v86, v[16:17] offset:128
    v_pk_mul_f32 v[28:29], v[14:15], v[52:53] op_sel:[0,0] op_sel_hi:[1,0]
    v_pk_fma_f32 v[14:15], v[14:15], v[52:53], v[28:29] op_sel:[1,1,0] op_sel_hi:[0,1,1] neg_lo:[1,0,0]
    ds_write_b64 v86, v[14:15] offset:192
    v_pk_mul_f32 v[10:11], v[24:25], v[54:55] op_sel:[0,0] op_sel_hi:[1,0]
    v_pk_fma_f32 v[24:25], v[24:25], v[54:55], v[10:11] op_sel:[1,1,0] op_sel_hi:[0,1,1] neg_lo:[1,0,0]
    ds_write_b64 v86, v[24:25] offset:256
    v_pk_mul_f32 v[28:29], v[26:27], v[56:57] op_sel:[0,0] op_sel_hi:[1,0]
    v_pk_fma_f32 v[26:27], v[26:27], v[56:57], v[28:29] op_sel:[1,1,0] op_sel_hi:[0,1,1] neg_lo:[1,0,0]
    ds_write_b64 v86, v[26:27] offset:320
    v_pk_mul_f32 v[10:11], v[30:31], v[58:59] op_sel:[0,0] op_sel_hi:[1,0]
    v_pk_fma_f32 v[30:31], v[30:31], v[58:59], v[10:11] op_sel:[1,1,0] op_sel_hi:[0,1,1] neg_lo:[1,0,0]
    ds_write_b64 v86, v[30:31] offset:384
    v_pk_mul_f32 v[28:29], v[22:23], v[60:61] op_sel:[0,0] op_sel_hi:[1,0]
    v_pk_fma_f32 v[22:23], v[22:23], v[60:61], v[28:29] op_sel:[1,1,0] op_sel_hi:[0,1,1] neg_lo:[1,0,0]
    ds_write_b64 v86, v[22:23] offset:448
    ds_read_b64 v[8:9], v87 offset:0
    ds_read_b64 v[18:19], v87 offset:576
    ds_read_b64 v[16:17], v87 offset:1152
    ds_read_b64 v[14:15], v87 offset:1728
    ds_read_b64 v[24:25], v87 offset:2304
    ds_read_b64 v[26:27], v87 offset:2880
    ds_read_b64 v[30:31], v87 offset:3456
    ds_read_b64 v[22:23], v87 offset:4032
    s_waitcnt lgkmcnt(0)
    v_pk_add_f32 v[12:13], v[8:9], v[24:25] neg_lo:[0,1] neg_hi:[0,1]
    v_pk_add_f32 v[8:9], v[8:9], v[24:25]
    v_pk_add_f32 v[24:25], v[18:19], v[26:27] neg_lo:[0,1] neg_hi:[0,1]
    v_pk_add_f32 v[18:19], v[18:19], v[26:27]
    v_pk_add_f32 v[26:27], v[16:17], v[30:31] neg_lo:[0,1] neg_hi:[0,1]
    v_pk_add_f32 v[16:17], v[16:17], v[30:31]
    v_pk_add_f32 v[30:31], v[14:15], v[22:23] neg_lo:[0,1] neg_hi:[0,1]
    v_pk_add_f32 v[14:15], v[14:15], v[22:23]
    v_pk_add_f32 v[22:23], v[24:25], v[24:25] op_sel:[1,0] op_sel_hi:[0,1] neg_hi:[1,0]
    v_pk_add_f32 v[20:21], v[30:31], v[30:31] op_sel:[1,0] op_sel_hi:[0,1] neg_hi:[1,0]
    v_pk_add_f32 v[28:29], v[8:9], v[16:17] neg_lo:[0,1] neg_hi:[0,1]
    v_pk_add_f32 v[8:9], v[8:9], v[16:17]
    v_pk_add_f32 v[16:17], v[18:19], v[14:15] neg_lo:[0,1] neg_hi:[0,1]
    v_pk_add_f32 v[18:19], v[18:19], v[14:15]
    v_pk_add_f32 v[14:15], v[26:27], v[12:13] op_sel:[1,0] op_sel_hi:[0,1] neg_lo:[1,0]
    v_pk_add_f32 v[12:13], v[26:27], v[12:13] op_sel:[1,0] op_sel_hi:[0,1] neg_hi:[1,0]
    v_pk_add_f32 v[26:27], v[20:21], v[22:23] op_sel:[1,0] op_sel_hi:[0,1] neg_lo:[1,0]
    v_pk_add_f32 v[22:23], v[20:21], v[22:23] op_sel:[1,0] op_sel_hi:[0,1] neg_hi:[1,0]
    v_pk_add_f32 v[20:21], v[8:9], v[18:19] neg_lo:[0,1] neg_hi:[0,1]
    v_pk_add_f32 v[8:9], v[8:9], v[18:19]
    v_pk_add_f32 v[18:19], v[16:17], v[28:29] op_sel:[1,0] op_sel_hi:[0,1] neg_lo:[1,0]
    v_pk_add_f32 v[28:29], v[16:17], v[28:29] op_sel:[1,0] op_sel_hi:[0,1] neg_hi:[1,0]
    v_pk_fma_f32 v[16:17], v[22:23], s[26:27], v[12:13] neg_lo:[1,0,0] neg_hi:[1,0,0]
    v_pk_fma_f32 v[12:13], v[22:23], s[26:27], v[12:13]
    v_pk_fma_f32 v[22:23], v[26:27], s[26:27], v[14:15] op_sel:[1,0,0] op_sel_hi:[0,1,1] neg_lo:[1,0,0]
    v_pk_fma_f32 v[14:15], v[26:27], s[26:27], v[14:15] op_sel:[1,0,0] op_sel_hi:[0,1,1] neg_hi:[1,0,0]
    s_cmp_eq_u32 s29, 0
    s_cbranch_scc1 M_C0
    s_waitcnt vmcnt(0)
    v_lshlrev_b32 v100, 16, v64
    v_and_b32 v101, s63, v64
    v_mul_f32 v100, s52, v100
    v_mul_f32 v101, s52, v101
    v_lshlrev_b32 v102, 16, v65
    v_and_b32 v103, s63, v65
    v_mul_f32 v102, s52, v102
    v_mul_f32 v103, s52, v103
    v_lshlrev_b32 v104, 16, v66
    v_and_b32 v105, s63, v66
    v_mul_f32 v104, s52, v104
    v_mul_f32 v105, s52, v105
    v_lshlrev_b32 v106, 16, v67
    v_and_b32 v107, s63, v67
    v_mul_f32 v106, s52, v106
    v_mul_f32 v107, s52, v107
    v_lshlrev_b32 v108, 16, v68
    v_and_b32 v109, s63, v68
    v_mul_f32 v108, s52, v108
    v_mul_f32 v109, s52, v109
    v_lshlrev_b32 v110, 16, v69
    v_and_b32 v111, s63, v69
    v_mul_f32 v110, s52, v110
    v_mul_f32 v111, s52, v111
    v_lshlrev_b32 v112, 16, v70
    v_and_b32 v113, s63, v70
    v_mul_f32 v112, s52, v112
    v_mul_f32 v113, s52, v113
    v_lshlrev_b32 v114, 16, v71
    v_and_b32 v115, s63, v71
    v_mul_f32 v114, s52, v114
    v_mul_f32 v115, s52, v115
    v_pk_mul_f32 v[88:89], v[8:9], v[100:101] op_sel:[0,0] op_sel_hi:[1,0]
    v_pk_fma_f32 v[8:9], v[8:9], v[100:101], v[88:89] op_sel:[1,1,0] op_sel_hi:[0,1,1] neg_lo:[1,0,0]
    v_pk_mul_f32 v[90:91], v[12:13], v[102:103] op_sel:[0,0] op_sel_hi:[1,0]
    v_pk_fma_f32 v[12:13], v[12:13], v[102:103], v[90:91] op_sel:[1,1,0] op_sel_hi:[0,1,1] neg_lo:[1,0,0]
    v_pk_mul_f32 v[88:89], v[28:29], v[104:105] op_sel:[0,0] op_sel_hi:[1,0]
    v_pk_fma_f32 v[28:29], v[28:29], v[104:105], v[88:89] op_sel:[1,1,0] op_sel_hi:[0,1,1] neg_lo:[1,0,0]
    v_pk_mul_f32 v[90:91], v[14:15], v[106:107] op_sel:[0,0] op_sel_hi:[1,0]
    v_pk_fma_f32 v[14:15], v[14:15], v[106:107], v[90:91] op_sel:[1,1,0] op_sel_hi:[0,1,1] neg_lo:[1,0,0]
    v_pk_mul_f32 v[88:89], v[20:21], v[108:109] op_sel:[0,0] op_sel_hi:[1,0]
    v_pk_fma_f32 v[20:21], v[20:21], v[108:109], v[88:89] op_sel:[1,1,0] op_sel_hi:[0,1,1] neg_lo:[1,0,0]
    v_pk_mul_f32 v[90:91], v[16:17], v[110:111] op_sel:[0,0] op_sel_hi:[1,0]
    v_pk_fma_f32 v[16:17], v[16:17], v[110:111], v[90:91] op_sel:[1,1,0] op_sel_hi:[0,1,1] neg_lo:[1,0,0]
    v_pk_mul_f32 v[88:89], v[18:19], v[112:113] op_sel:[0,0] op_sel_hi:[1,0]
    v_pk_fma_f32 v[18:19], v[18:19], v[112:113], v[88:89] op_sel:[1,1,0] op_sel_hi:[0,1,1] neg_lo:[1,0,0]
    v_pk_mul_f32 v[90:91], v[22:23], v[114:115] op_sel:[0,0] op_sel_hi:[1,0]
    v_pk_fma_f32 v[22:23], v[22:23], v[114:115], v[90:91] op_sel:[1,1,0] op_sel_hi:[0,1,1] neg_lo:[1,0,0]
M_C0B:
    v_pk_add_f32 v[26:27], v[8:9], v[20:21] neg_lo:[0,1] neg_hi:[0,1]
    v_pk_add_f32 v[8:9], v[8:9], v[20:21]
    v_pk_add_f32 v[20:21], v[12:13], v[16:17] neg_lo:[0,1] neg_hi:[0,1]
    v_pk_add_f32 v[12:13], v[12:13], v[16:17]
    v_pk_add_f32 v[16:17], v[28:29], v[18:19] neg_lo:[0,1] neg_hi:[0,1]
    v_pk_add_f32 v[28:29], v[28:29], v[18:19]
    v_pk_add_f32 v[18:19], v[14:15], v[22:23] neg_lo:[0,1] neg_hi:[0,1]
    v_pk_add_f32 v[14:15], v[14:15], v[22:23]
    v_pk_add_f32 v[22:23], v[20:21], v[20:21] op_sel:[1,0] op_sel_hi:[0,1] neg_lo:[1,0]
    v_pk_add_f32 v[10:11], v[18:19], v[18:19] op_sel:[1,0] op_sel_hi:[0,1] neg_lo:[1,0]
    v_pk_add_f32 v[24:25], v[8:9], v[28:29] neg_lo:[0,1] neg_hi:[0,1]
    v_pk_add_f32 v[8:9], v[8:9], v[28:29]
    v_pk_add_f32 v[28:29], v[12:13], v[14:15] neg_lo:[0,1] neg_hi:[0,1]
    v_pk_add_f32 v[12:13], v[12:13], v[14:15]
    v_pk_add_f32 v[14:15], v[16:17], v[26:27] op_sel:[1,0] op_sel_hi:[0,1] neg_hi:[1,0]
    v_pk_add_f32 v[26:27], v[16:17], v[26:27] op_sel:[1,0] op_sel_hi:[0,1] neg_lo:[1,0]
    v_pk_add_f32 v[16:17], v[10:11], v[22:23] op_sel:[1,0] op_sel_hi:[0,1] neg_hi:[1,0]
    v_pk_add_f32 v[22:23], v[10:11], v[22:23] op_sel:[1,0] op_sel_hi:[0,1] neg_lo:[1,0]
    v_pk_add_f32 v[10:11], v[8:9], v[12:13] neg_lo:[0,1] neg_hi:[0,1]
    v_pk_add_f32 v[8:9], v[8:9], v[12:13]
    v_pk_add_f32 v[12:13], v[28:29], v[24:25] op_sel:[1,0] op_sel_hi:[0,1] neg_hi:[1,0]
    v_pk_add_f32 v[24:25], v[28:29], v[24:25] op_sel:[1,0] op_sel_hi:[0,1] neg_lo:[1,0]
    v_pk_fma_f32 v[28:29], v[22:23], s[26:27], v[26:27] neg_lo:[1,0,0] neg_hi:[1,0,0]
    v_pk_fma_f32 v[26:27], v[22:23], s[26:27], v[26:27]
    v_pk_fma_f32 v[22:23], v[16:17], s[26:27], v[14:15] op_sel:[1,0,0] op_sel_hi:[0,1,1] neg_hi:[1,0,0]
    v_pk_fma_f32 v[14:15], v[16:17], s[26:27], v[14:15] op_sel:[1,0,0] op_sel_hi:[0,1,1] neg_lo:[1,0,0]
    ds_write_b64 v84, v[8:9]
    v_pk_mul_f32 v[20:21], v[26:27], v[32:33] op_sel:[0,0] op_sel_hi:[1,0]
    v_pk_fma_f32 v[26:27], v[26:27], v[32:33], v[20:21] op_sel:[1,1,0] op_sel_hi:[0,1,1] neg_hi:[1,0,0]
    ds_write_b64 v84, v[26:27] offset:8
    v_pk_mul_f32 v[18:19], v[24:25], v[34:35] op_sel:[0,0] op_sel_hi:[1,0]
    v_pk_fma_f32 v[24:25], v[24:25], v[34:35], v[18:19] op_sel:[1,1,0] op_sel_hi:[0,1,1] neg_hi:[1,0,0]
    ds_write_b64 v84, v[24:25] offset:16
    v_pk_mul_f32 v[20:21], v[14:15], v[36:37] op_sel:[0,0] op_sel_hi:[1,0]
    v_pk_fma_f32 v[14:15], v[14:15], v[36:37], v[20:21] op_sel:[1,1,0] op_sel_hi:[0,1,1] neg_hi:[1,0,0]
    ds_write_b64 v84, v[14:15] offset:24
    v_pk_mul_f32 v[18:19], v[10:11], v[38:39] op_sel:[0,0] op_sel_hi:[1,0]
    v_pk_fma_f32 v[10:11], v[10:11], v[38:39], v[18:19] op_sel:[1,1,0] op_sel_hi:[0,1,1] neg_hi:[1,0,0]
    ds_write_b64 v84, v[10:11] offset:32
    v_pk_mul_f32 v[20:21], v[28:29], v[40:41] op_sel:[0,0] op_sel_hi:[1,0]
    v_pk_fma_f32 v[28:29], v[28:29], v[40:41], v[20:21] op_sel:[1,1,0] op_sel_hi:[0,1,1] neg_hi:[1,0,0]
    ds_write_b64 v84, v[28:29] offset:40
    v_pk_mul_f32 v[18:19], v[12:13], v[42:43] op_sel:[0,0] op_sel_hi:[1,0]
    v_pk_fma_f32 v[12:13], v[12:13], v[42:43], v[18:19] op_sel:[1,1,0] op_sel_hi:[0,1,1] neg_hi:[1,0,0]
    ds_write_b64 v84, v[12:13] offset:48
    v_pk_mul_f32 v[20:21], v[22:23], v[44:45] op_sel:[0,0] op_sel_hi:[1,0]
    v_pk_fma_f32 v[22:23], v[22:23], v[44:45], v[20:21] op_sel:[1,1,0] op_sel_hi:[0,1,1] neg_hi:[1,0,0]
    ds_write_b64 v84, v[22:23] offset:56
    ds_read_b64 v[8:9], v85 offset:0
    ds_read_b64 v[26:27], v85 offset:576
    ds_read_b64 v[24:25], v85 offset:1152
    ds_read_b64 v[14:15], v85 offset:1728
    ds_read_b64 v[10:11], v85 offset:2304
    ds_read_b64 v[28:29], v85 offset:2880
    ds_read_b64 v[12:13], v85 offset:3456
    ds_read_b64 v[22:23], v85 offset:4032
    s_waitcnt lgkmcnt(0)
    v_pk_add_f32 v[16:17], v[8:9], v[10:11] neg_lo:[0,1] neg_hi:[0,1]
    v_pk_add_f32 v[8:9], v[8:9], v[10:11]
    v_pk_add_f32 v[10:11], v[26:27], v[28:29] neg_lo:[0,1] neg_hi:[0,1]
    v_pk_add_f32 v[26:27], v[26:27], v[28:29]
    v_pk_add_f32 v[28:29], v[24:25], v[12:13] neg_lo:[0,1] neg_hi:[0,1]
    v_pk_add_f32 v[24:25], v[24:25], v[12:13]
    v_pk_add_f32 v[12:13], v[14:15], v[22:23] neg_lo:[0,1] neg_hi:[0,1]
    v_pk_add_f32 v[14:15], v[14:15], v[22:23]
    v_pk_add_f32 v[22:23], v[10:11], v[10:11] op_sel:[1,0] op_sel_hi:[0,1] neg_lo:[1,0]
    v_pk_add_f32 v[30:31], v[12:13], v[12:13] op_sel:[1,0] op_sel_hi:[0,1] neg_lo:[1,0]
    v_pk_add_f32 v[20:21], v[8:9], v[24:25] neg_lo:[0,1] neg_hi:[0,1]
    v_pk_add_f32 v[8:9], v[8:9], v[24:25]
    v_pk_add_f32 v[24:25], v[26:27], v[14:15] neg_lo:[0,1] neg_hi:[0,1]
    v_pk_add_f32 v[26:27], v[26:27], v[14:15]
    v_pk_add_f32 v[14:15], v[28:29], v[16:17] op_sel:[1,0] op_sel_hi:[0,1] neg_hi:[1,0]
    v_pk_add_f32 v[16:17], v[28:29], v[16:17] op_sel:[1,0] op_sel_hi:[0,1] neg_lo:[1,0]
    v_pk_add_f32 v[28:29], v[30:31], v[22:23] op_sel:[1,0] op_sel_hi:[0,1] neg_hi:[1,0]
    v_pk_add_f32 v[22:23], v[30:31], v[22:23] op_sel:[1,0] op_sel_hi:[0,1] neg_lo:[1,0]
    v_pk_add_f32 v[30:31], v[8:9], v[26:27] neg_lo:[0,1] neg_hi:[0,1]
    v_pk_add_f32 v[8:9], v[8:9], v[26:27]
    v_pk_add_f32 v[26:27], v[24:25], v[20:21] op_sel:[1,0] op_sel_hi:[0,1] neg_hi:[1,0]
    v_pk_add_f32 v[20:21], v[24:25], v[20:21] op_sel:[1,0] op_sel_hi:[0,1] neg_lo:[1,0]
    v_pk_fma_f32 v[24:25], v[22:23], s[26:27], v[16:17] neg_lo:[1,0,0] neg_hi:[1,0,0]
    v_pk_fma_f32 v[16:17], v[22:23], s[26:27], v[16:17]
    v_pk_fma_f32 v[22:23], v[28:29], s[26:27], v[14:15] op_sel:[1,0,0] op_sel_hi:[0,1,1] neg_hi:[1,0,0]
    v_pk_fma_f32 v[14:15], v[28:29], s[26:27], v[14:15] op_sel:[1,0,0] op_sel_hi:[0,1,1] neg_lo:[1,0,0]
    v_pk_mul_f32 v[12:13], v[8:9], v[46:47] op_sel:[0,0] op_sel_hi:[1,0]
    v_pk_fma_f32 v[8:9], v[8:9], v[46:47], v[12:13] op_sel:[1,1,0] op_sel_hi:[0,1,1] neg_hi:[1,0,0]
    ds_write_b64 v86, v[8:9] offset:0
    v_pk_mul_f32 v[10:11], v[16:17], v[48:49] op_sel:[0,0] op_sel_hi:[1,0]
    v_pk_fma_f32 v[16:17], v[16:17], v[48:49], v[10:11] op_sel:[1,1,0] op_sel_hi:[0,1,1] neg_hi:[1,0,0]
    ds_write_b64 v86, v[16:17] offset:64
    v_pk_mul_f32 v[12:13], v[20:21], v[50:51] op_sel:[0,0] op_sel_hi:[1,0]
    v_pk_fma_f32 v[20:21], v[20:21], v[50:51], v[12:13] op_sel:[1,1,0] op_sel_hi:[0,1,1] neg_hi:[1,0,0]
    ds_write_b64 v86, v[20:21] offset:128
    v_pk_mul_f32 v[10:11], v[14:15], v[52:53] op_sel:[0,0] op_sel_hi:[1,0]
    v_pk_fma_f32 v[14:15], v[14:15], v[52:53], v[10:11] op_sel:[1,1,0] op_sel_hi:[0,1,1] neg_hi:[1,0,0]
    ds_write_b64 v86, v[14:15] offset:192
    v_pk_mul_f32 v[12:13], v[30:31], v[54:55] op_sel:[0,0] op_sel_hi:[1,0]
    v_pk_fma_f32 v[30:31], v[30:31], v[54:55], v[12:13] op_sel:[1,1,0] op_sel_hi:[0,1,1] neg_hi:[1,0,0]
    ds_write_b64 v86, v[30:31] offset:256
    v_pk_mul_f32 v[10:11], v[24:25], v[56:57] op_sel:[0,0] op_sel_hi:[1,0]
    v_pk_fma_f32 v[24:25], v[24:25], v[56:57], v[10:11] op_sel:[1,1,0] op_sel_hi:[0,1,1] neg_hi:[1,0,0]
    ds_write_b64 v86, v[24:25] offset:320
    v_pk_mul_f32 v[12:13], v[26:27], v[58:59] op_sel:[0,0] op_sel_hi:[1,0]
    v_pk_fma_f32 v[26:27], v[26:27], v[58:59], v[12:13] op_sel:[1,1,0] op_sel_hi:[0,1,1] neg_hi:[1,0,0]
    ds_write_b64 v86, v[26:27] offset:384
    v_pk_mul_f32 v[10:11], v[22:23], v[60:61] op_sel:[0,0] op_sel_hi:[1,0]
    v_pk_fma_f32 v[22:23], v[22:23], v[60:61], v[10:11] op_sel:[1,1,0] op_sel_hi:[0,1,1] neg_hi:[1,0,0]
    ds_write_b64 v86, v[22:23] offset:448
    ds_read_b64 v[8:9], v87 offset:0
    ds_read_b64 v[16:17], v87 offset:576
    ds_read_b64 v[20:21], v87 offset:1152
    ds_read_b64 v[14:15], v87 offset:1728
    ds_read_b64 v[30:31], v87 offset:2304
    ds_read_b64 v[24:25], v87 offset:2880
    ds_read_b64 v[26:27], v87 offset:3456
    ds_read_b64 v[22:23], v87 offset:4032
    s_waitcnt lgkmcnt(0)
    v_pk_add_f32 v[28:29], v[8:9], v[30:31] neg_lo:[0,1] neg_hi:[0,1]
    v_pk_add_f32 v[8:9], v[8:9], v[30:31]
    v_pk_add_f32 v[30:31], v[16:17], v[24:25] neg_lo:[0,1] neg_hi:[0,1]
    v_pk_add_f32 v[16:17], v[16:17], v[24:25]
    v_pk_add_f32 v[24:25], v[20:21], v[26:27] neg_lo:[0,1] neg_hi:[0,1]
    v_pk_add_f32 v[20:21], v[20:21], v[26:27]
    v_pk_add_f32 v[26:27], v[14:15], v[22:23] neg_lo:[0,1] neg_hi:[0,1]
    v_pk_add_f32 v[14:15], v[14:15], v[22:23]
    v_pk_add_f32 v[22:23], v[30:31], v[30:31] op_sel:[1,0] op_sel_hi:[0,1] neg_lo:[1,0]
    v_pk_add_f32 v[18:19], v[26:27], v[26:27] op_sel:[1,0] op_sel_hi:[0,1] neg_lo:[1,0]
    v_pk_add_f32 v[10:11], v[8:9], v[20:21] neg_lo:[0,1] neg_hi:[0,1]
    v_pk_add_f32 v[8:9], v[8:9], v[20:21]
    v_pk_add_f32 v[20:21], v[16:17], v[14:15] neg_lo:[0,1] neg_hi:[0,1]
    v_pk_add_f32 v[16:17], v[16:17], v[14:15]
    v_pk_add_f32 v[14:15], v[24:25], v[28:29] op_sel:[1,0] op_sel_hi:[0,1] neg_hi:[1,0]
    v_pk_add_f32 v[28:29], v[24:25], v[28:29] op_sel:[1,0] op_sel_hi:[0,1] neg_lo:[1,0]
    v_pk_add_f32 v[24:25], v[18:19], v[22:23] op_sel:[1,0] op_sel_hi:[0,1] neg_hi:[1,0]
    v_pk_add_f32 v[22:23], v[18:19], v[22:23] op_sel:[1,0] op_sel_hi:[0,1] neg_lo:[1,0]
    v_pk_add_f32 v[18:19], v[8:9], v[16:17] neg_lo:[0,1] neg_hi:[0,1]
    v_pk_add_f32 v[8:9], v[8:9], v[16:17]
    v_pk_add_f32 v[16:17], v[20:21], v[10:11] op_sel:[1,0] op_sel_hi:[0,1] neg_hi:[1,0]
    v_pk_add_f32 v[10:11], v[20:21], v[10:11] op_sel:[1,0] op_sel_hi:[0,1] neg_lo:[1,0]
    v_pk_fma_f32 v[20:21], v[22:23], s[26:27], v[28:29] neg_lo:[1,0,0] neg_hi:[1,0,0]
    v_pk_fma_f32 v[28:29], v[22:23], s[26:27], v[28:29]
    v_pk_fma_f32 v[22:23], v[24:25], s[26:27], v[14:15] op_sel:[1,0,0] op_sel_hi:[0,1,1] neg_hi:[1,0,0]
    v_pk_fma_f32 v[14:15], v[24:25], s[26:27], v[14:15] op_sel:[1,0,0] op_sel_hi:[0,1,1] neg_lo:[1,0,0]
    ds_write_b64 v87, v[8:9] offset:0
    ds_write_b64 v87, v[28:29] offset:512
    ds_write_b64 v87, v[10:11] offset:1024
    ds_write_b64 v87, v[14:15] offset:1536
    ds_write_b64 v87, v[18:19] offset:2048
    ds_write_b64 v87, v[20:21] offset:2560
    ds_write_b64 v87, v[16:17] offset:3072
    ds_write_b64 v87, v[22:23] offset:3584
    v_mov_b32 v99, 1
    s_mov_b64 exec, 1
    ds_add_rtn_u32 v99, v98, v99 offset:0
    s_mov_b64 exec, -1
    s_waitcnt lgkmcnt(0)
    v_readfirstlane_b32 s52, v99
    s_cmp_eq_u32 s52, 11
    s_cbranch_scc1 M_B5_X
    s_mov_b32 s52, 0
M_B5_L:
    ds_read_b32 v99, v98 offset:0
    s_add_u32 s52, s52, 1
    s_cmp_ge_u32 s52, 400000
    s_cbranch_scc1 M_B5_X
    s_waitcnt lgkmcnt(0)
    v_cmp_gt_u32 vcc, 12, v99
    s_cbranch_vccnz M_B5_L
M_B5_X:
    ds_read_b128 v[8:11], v94 offset:0
    ds_read_b128 v[12:15], v94 offset:4608
    ds_read_b128 v[16:19], v94 offset:9216
    ds_read_b128 v[20:23], v94 offset:13824
    s_waitcnt lgkmcnt(2)
    v_pk_mul_f32 v[88:89], v[12:13], v[148:149] op_sel:[0,0] op_sel_hi:[1,0]
    v_pk_fma_f32 v[12:13], v[12:13], v[148:149], v[88:89] op_sel:[1,1,0] op_sel_hi:[0,1,1] neg_hi:[1,0,0]
    v_pk_mul_f32 v[90:91], v[14:15], v[150:151] op_sel:[0,0] op_sel_hi:[1,0]
    v_pk_fma_f32 v[14:15], v[14:15], v[150:151], v[90:91] op_sel:[1,1,0] op_sel_hi:[0,1,1] neg_hi:[1,0,0]
    s_waitcnt lgkmcnt(1)
    v_pk_mul_f32 v[88:89], v[16:17], v[152:153] op_sel:[0,0] op_sel_hi:[1,0]
    v_pk_fma_f32 v[16:17], v[16:17], v[152:153], v[88:89] op_sel:[1,1,0] op_sel_hi:[0,1,1] neg_hi:[1,0,0]
    v_pk_mul_f32 v[90:91], v[18:19], v[154:155] op_sel:[0,0] op_sel_hi:[1,0]
    v_pk_fma_f32 v[18:19], v[18:19], v[154:155], v[90:91] op_sel:[1,1,0] op_sel_hi:[0,1,1] neg_hi:[1,0,0]
    s_waitcnt lgkmcnt(0)
    v_pk_mul_f32 v[88:89], v[20:21], v[156:157] op_sel:[0,0] op_sel_hi:[1,0]
    v_pk_fma_f32 v[20:21], v[20:21], v[156:157], v[88:89] op_sel:[1,1,0] op_sel_hi:[0,1,1] neg_hi:[1,0,0]
    v_pk_mul_f32 v[90:91], v[22:23], v[158:159] op_sel:[0,0] op_sel_hi:[1,0]
    v_pk_fma_f32 v[22:23], v[22:23], v[158:159], v[90:91] op_sel:[1,1,0] op_sel_hi:[0,1,1] neg_hi:[1,0,0]
    v_pk_add_f32 v[28:29], v[8:9], v[16:17] neg_lo:[0,1] neg_hi:[0,1]
    v_pk_add_f32 v[8:9], v[8:9], v[16:17]
    v_pk_add_f32 v[30:31], v[10:11], v[18:19] neg_lo:[0,1] neg_hi:[0,1]
    v_pk_add_f32 v[10:11], v[10:11], v[18:19]
    v_pk_add_f32 v[16:17], v[12:13], v[20:21] neg_lo:[0,1] neg_hi:[0,1]
    v_pk_add_f32 v[12:13], v[12:13], v[20:21]
    v_pk_add_f32 v[18:19], v[14:15], v[22:23] neg_lo:[0,1] neg_hi:[0,1]
    v_pk_add_f32 v[14:15], v[14:15], v[22:23]
    v_pk_add_f32 v[20:21], v[8:9], v[12:13] neg_lo:[0,1] neg_hi:[0,1]
    v_pk_add_f32 v[8:9], v[8:9], v[12:13]
    v_pk_add_f32 v[22:23], v[10:11], v[14:15] neg_lo:[0,1] neg_hi:[0,1]
    v_pk_add_f32 v[10:11], v[10:11], v[14:15]
    v_pk_add_f32 v[12:13], v[16:17], v[28:29] op_sel:[1,0] op_sel_hi:[0,1] neg_hi:[1,0]
    v_pk_add_f32 v[28:29], v[16:17], v[28:29] op_sel:[1,0] op_sel_hi:[0,1] neg_lo:[1,0]
    v_pk_add_f32 v[14:15], v[18:19], v[30:31] op_sel:[1,0] op_sel_hi:[0,1] neg_hi:[1,0]
    v_pk_add_f32 v[30:31], v[18:19], v[30:31] op_sel:[1,0] op_sel_hi:[0,1] neg_lo:[1,0]
    v_bfi_b32 v8, 3, v136, v8
    v_bfi_b32 v9, 3, v137, v9
    v_bfi_b32 v10, 3, v138, v10
    v_bfi_b32 v11, 3, v139, v11
    buffer_store_dwordx4 v[8:11], v92, s[4:7], s58 offen sc1
    v_bfi_b32 v28, 3, v136, v28
    v_bfi_b32 v29, 3, v137, v29
    v_bfi_b32 v30, 3, v138, v30
    v_bfi_b32 v31, 3, v139, v31
    buffer_store_dwordx4 v[28:31], v92, s[4:7], s59 offen sc1
    v_bfi_b32 v20, 3, v136, v20
    v_bfi_b32 v21, 3, v137, v21
    v_bfi_b32 v22, 3, v138, v22
    v_bfi_b32 v23, 3, v139, v23
    buffer_store_dwordx4 v[20:23], v92, s[4:7], s60 offen sc1
    v_bfi_b32 v12, 3, v136, v12
    v_bfi_b32 v13, 3, v137, v13
    v_bfi_b32 v14, 3, v138, v14
    v_bfi_b32 v15, 3, v139, v15
    buffer_store_dwordx4 v[12:15], v92, s[4:7], s61 offen sc1
    s_lshl_b32 s57, s30, 4
    s_add_u32 s57, s57, s31
    s_lshl_b32 s54, s57, 6
    s_lshl_b32 s53, s24, 18
    s_add_u32 s54, s54, s53
    s_add_u32 s54, s54, 7340032
    s_lshl_b32 s55, s24, 10
    s_add_u32 s55, s55, 18432
    s_lshl_b32 s56, s57, 14
    s_lshl_b32 s53, s24, 12
    s_add_u32 s56, s56, s53
    s_add_u32 s56, s56, 18874368
    v_lshrrev_b32 v4, 2, v1
    v_lshlrev_b32 v64, 14, v4
    v_lshrrev_b32 v5, 4, v1
    v_xor_b32 v5, v5, v1
    v_and_b32 v5, 3, v5
    v_lshl_add_u32 v64, v5, 4, v64
    v_xor_b32 v5, s24, v4
    v_and_b32 v5, 3, v5
    v_lshlrev_b32 v5, 4, v5
    v_lshl_add_u32 v65, v1, 6, v5
    v_add_u32 v65, 18432, v65
    v_sub_u32 v6, 64, v1
    v_lshrrev_b32 v5, 2, v6
    v_xor_b32 v5, s24, v5
    v_and_b32 v5, 3, v5
    v_lshlrev_b32 v5, 4, v5
    v_lshl_add_u32 v66, v6, 6, v5
    v_add_u32 v66, 18432, v66
    v_lshlrev_b32 v67, 2, v1
    v_add_u32 v67, s28, v67
    v_lshlrev_b32 v68, 4, v1
    v_add_u32 v68, s28, v68
    v_add_u32 v69, s55, v93
    s_add_u32 s60, s54, 1048576
    s_add_u32 s61, s54, 2097152
    s_add_u32 s62, s54, 3145728
    s_waitcnt vmcnt(0)
    s_setprio 3
    s_mov_b32 s52, 0
M_P3P_L:
    buffer_load_dwordx4 v[100:103], v64, s[4:7], s54 offen sc1
    buffer_load_dwordx4 v[104:107], v64, s[4:7], s60 offen sc1
    buffer_load_dwordx4 v[108:111], v64, s[4:7], s61 offen sc1
    buffer_load_dwordx4 v[112:115], v64, s[4:7], s62 offen sc1
    s_waitcnt vmcnt(3)
    v_alignbit_b32 v6, v100, v6, 2
    v_and_b32 v100, -4, v100
    v_alignbit_b32 v6, v101, v6, 2
    v_and_b32 v101, -4, v101
    v_alignbit_b32 v6, v102, v6, 2
    v_and_b32 v102, -4, v102
    v_alignbit_b32 v6, v103, v6, 2
    v_and_b32 v103, -4, v103
    s_waitcnt vmcnt(2)
    v_alignbit_b32 v6, v104, v6, 2
    v_and_b32 v104, -4, v104
    v_alignbit_b32 v6, v105, v6, 2
    v_and_b32 v105, -4, v105
    v_alignbit_b32 v6, v106, v6, 2
    v_and_b32 v106, -4, v106
    v_alignbit_b32 v6, v107, v6, 2
    v_and_b32 v107, -4, v107
    s_waitcnt vmcnt(1)
    v_alignbit_b32 v6, v108, v6, 2
    v_and_b32 v108, -4, v108
    v_alignbit_b32 v6, v109, v6, 2
    v_and_b32 v109, -4, v109
    v_alignbit_b32 v6, v110, v6, 2
    v_and_b32 v110, -4, v110
    v_alignbit_b32 v6, v111, v6, 2
    v_and_b32 v111, -4, v111
    s_waitcnt vmcnt(0)
    v_alignbit_b32 v6, v112, v6, 2
    v_and_b32 v112, -4, v112
    v_alignbit_b32 v6, v113, v6, 2
    v_and_b32 v113, -4, v113
    v_alignbit_b32 v6, v114, v6, 2
    v_and_b32 v114, -4, v114
    v_alignbit_b32 v6, v115, v6, 2
    v_and_b32 v115, -4, v115
    v_xor_b32 v6, v141, v6
    s_nop 1
    v_or_b32_dpp v6, v6, v6 quad_perm:[1,0,3,2] row_mask:0xf bank_mask:0xf
    s_nop 1
    v_or_b32_dpp v6, v6, v6 quad_perm:[2,3,0,1] row_mask:0xf bank_mask:0xf
    v_cmp_ne_u32 vcc, 0, v6
    s_nop 4
    s_mov_b64 exec, vcc
    s_add_u32 s52, s52, 1
    s_cmp_ge_u32 s52, 100000
    s_cbranch_scc1 M_P3P_X
    s_nop 3
    s_cmp_eq_u64 vcc, 0
    s_cbranch_scc1 M_P3P_X
    s_sleep 1
    s_branch M_P3P_L
M_P3P_X:
    s_mov_b64 exec, -1
    ds_write_b128 v69, v[100:103] offset:0
    ds_write_b128 v69, v[104:107] offset:4096
    ds_write_b128 v69, v[108:111] offset:8192
    ds_write_b128 v69, v[112:115] offset:12288
    s_mov_b32 s58, 0xffff
    v_and_b32 v136, s58, v97
    v_lshrrev_b32 v137, 16, v97
    v_mov_b32 v99, 1
    s_mov_b64 exec, 1
    ds_add_rtn_u32 v99, v98, v99 offset:0
    s_mov_b64 exec, -1
    s_waitcnt lgkmcnt(0)
    v_readfirstlane_b32 s52, v99
    s_cmp_eq_u32 s52, 15
    s_cbranch_scc1 M_B8_X
    s_mov_b32 s52, 0
M_B8_L:
    ds_read_b32 v99, v98 offset:0
    s_add_u32 s52, s52, 1
    s_cmp_ge_u32 s52, 400000
    s_cbranch_scc1 M_B8_X
    s_waitcnt lgkmcnt(0)
    v_cmp_gt_u32 vcc, 16, v99
    s_cbranch_vccnz M_B8_L
M_B8_X:
    v_cmp_eq_u32 vcc, 0, v1
    ds_read_b128 v[100:103], v65 offset:0
    ds_read_b128 v[104:107], v65 offset:4096
    ds_read_b128 v[108:111], v65 offset:8192
    ds_read_b128 v[112:115], v65 offset:12288
    ds_read_b128 v[116:119], v66 offset:12288
    ds_read_b128 v[120:123], v66 offset:8192
    ds_read_b128 v[124:127], v66 offset:4096
    ds_read_b128 v[128:131], v66 offset:0
    s_waitcnt lgkmcnt(7)
    v_mov_b32 v70, v101
    v_mov_b32 v71, v103
    v_cndmask_b32 v101, v101, v3, vcc
    v_cndmask_b32 v103, v103, v3, vcc
    v_sub_f32 v8, v100, v103
    v_add_f32 v9, v101, v102
    s_waitcnt lgkmcnt(6)
    v_sub_f32 v10, v104, v107
    v_add_f32 v11, v105, v106
    s_waitcnt lgkmcnt(5)
    v_sub_f32 v12, v108, v111
    v_add_f32 v13, v109, v110
    s_waitcnt lgkmcnt(4)
    v_sub_f32 v14, v112, v115
    v_add_f32 v15, v113, v114
    s_waitcnt lgkmcnt(3)
    v_cndmask_b32 v116, v116, v70, vcc
    v_cndmask_b32 v118, v118, v71, vcc
    v_cndmask_b32 v117, v117, v3, vcc
    v_cndmask_b32 v119, v119, v3, vcc
    v_add_f32 v16, v119, v116
    v_sub_f32 v17, v118, v117
    s_waitcnt lgkmcnt(2)
    v_add_f32 v18, v123, v120
    v_sub_f32 v19, v122, v121
    s_waitcnt lgkmcnt(1)
    v_add_f32 v20, v127, v124
    v_sub_f32 v21, v126, v125
    s_waitcnt lgkmcnt(0)
    v_add_f32 v22, v131, v128
    v_sub_f32 v23, v130, v129
    v_sub_f32 v30, v8, v16
    v_sub_f32 v31, v9, v17
    v_add_f32 v8, v8, v16
    v_add_f32 v9, v9, v17
    v_sub_f32 v16, v10, v18
    v_sub_f32 v17, v11, v19
    v_add_f32 v10, v10, v18
    v_add_f32 v11, v11, v19
    v_sub_f32 v18, v12, v20
    v_sub_f32 v19, v13, v21
    v_add_f32 v12, v12, v20
    v_add_f32 v13, v13, v21
    v_sub_f32 v20, v14, v22
    v_sub_f32 v21, v15, v23
    v_add_f32 v14, v14, v22
    v_add_f32 v15, v15, v23
    v_sub_f32 v22, v16, v17
    v_add_f32 v23, v17, v16
    v_sub_f32 v28, v20, v21
    v_add_f32 v29, v21, v20
    v_sub_f32 v26, v8, v12
    v_sub_f32 v27, v9, v13
    v_add_f32 v8, v8, v12
    v_add_f32 v9, v9, v13
    v_sub_f32 v12, v10, v14
    v_sub_f32 v13, v11, v15
    v_add_f32 v10, v10, v14
    v_add_f32 v11, v11, v15
    v_add_f32 v14, v30, v19
    v_sub_f32 v15, v31, v18
    v_sub_f32 v30, v30, v19
    v_add_f32 v31, v31, v18
    v_add_f32 v18, v22, v29
    v_sub_f32 v19, v23, v28
    v_sub_f32 v22, v22, v29
    v_add_f32 v23, v23, v28
    v_sub_f32 v28, v8, v10
    v_sub_f32 v29, v9, v11
    v_add_f32 v8, v8, v10
    v_add_f32 v9, v9, v11
    v_add_f32 v10, v26, v13
    v_sub_f32 v11, v27, v12
    v_sub_f32 v26, v26, v13
    v_add_f32 v27, v27, v12
    v_fma_f32 v12, -v22, s26, v30
    v_fma_f32 v13, -v23, s26, v31
    v_fma_f32 v30, v22, s26, v30
    v_fma_f32 v31, v23, s26, v31
    v_fma_f32 v22, v19, s26, v14
    v_fma_f32 v23, -v18, s26, v15
    v_fma_f32 v14, -v19, s26, v14
    v_fma_f32 v15, v18, s26, v15
    ds_write_b64 v84, v[8:9]
    v_mul_f32 v16, v30, v32
    v_mul_f32 v17, v30, v33
    v_fma_f32 v30, v31, v33, v16
    v_fma_f32 v31, v31, v32, -v17
    ds_write_b64 v84, v[30:31] offset:8
    v_mul_f32 v20, v26, v34
    v_mul_f32 v21, v26, v35
    v_fma_f32 v26, v27, v35, v20
    v_fma_f32 v27, v27, v34, -v21
    ds_write_b64 v84, v[26:27] offset:16
    v_mul_f32 v16, v14, v36
    v_mul_f32 v17, v14, v37
    v_fma_f32 v14, v15, v37, v16
    v_fma_f32 v15, v15, v36, -v17
    ds_write_b64 v84, v[14:15] offset:24
    v_mul_f32 v20, v28, v38
    v_mul_f32 v21, v28, v39
    v_fma_f32 v28, v29, v39, v20
    v_fma_f32 v29, v29, v38, -v21
    ds_write_b64 v84, v[28:29] offset:32
    v_mul_f32 v16, v12, v40
    v_mul_f32 v17, v12, v41
    v_fma_f32 v12, v13, v41, v16
    v_fma_f32 v13, v13, v40, -v17
    ds_write_b64 v84, v[12:13] offset:40
    v_mul_f32 v20, v10, v42
    v_mul_f32 v21, v10, v43
    v_fma_f32 v10, v11, v43, v20
    v_fma_f32 v11, v11, v42, -v21
    ds_write_b64 v84, v[10:11] offset:48
    v_mul_f32 v16, v22, v44
    v_mul_f32 v17, v22, v45
    v_fma_f32 v22, v23, v45, v16
    v_fma_f32 v23, v23, v44, -v17
    ds_write_b64 v84, v[22:23] offset:56
    ds_read_b64 v[8:9], v85 offset:0
    ds_read_b64 v[30:31], v85 offset:576
    ds_read_b64 v[26:27], v85 offset:1152
    ds_read_b64 v[14:15], v85 offset:1728
    ds_read_b64 v[28:29], v85 offset:2304
    ds_read_b64 v[12:13], v85 offset:2880
    ds_read_b64 v[10:11], v85 offset:3456
    ds_read_b64 v[22:23], v85 offset:4032
    s_waitcnt lgkmcnt(0)
    v_sub_f32 v18, v8, v28
    v_sub_f32 v19, v9, v29
    v_add_f32 v8, v8, v28
    v_add_f32 v9, v9, v29
    v_sub_f32 v28, v30, v12
    v_sub_f32 v29, v31, v13
    v_add_f32 v30, v30, v12
    v_add_f32 v31, v31, v13
    v_sub_f32 v12, v26, v10
    v_sub_f32 v13, v27, v11
    v_add_f32 v26, v26, v10
    v_add_f32 v27, v27, v11
    v_sub_f32 v10, v14, v22
    v_sub_f32 v11, v15, v23
    v_add_f32 v14, v14, v22
    v_add_f32 v15, v15, v23
    v_sub_f32 v22, v28, v29
    v_add_f32 v23, v29, v28
    v_sub_f32 v24, v10, v11
    v_add_f32 v25, v11, v10
    v_sub_f32 v16, v8, v26
    v_sub_f32 v17, v9, v27
    v_add_f32 v8, v8, v26
    v_add_f32 v9, v9, v27
    v_sub_f32 v26, v30, v14
    v_sub_f32 v27, v31, v15
    v_add_f32 v30, v30, v14
    v_add_f32 v31, v31, v15
    v_add_f32 v14, v18, v13
    v_sub_f32 v15, v19, v12
    v_sub_f32 v18, v18, v13
    v_add_f32 v19, v19, v12
    v_add_f32 v12, v22, v25
    v_sub_f32 v13, v23, v24
    v_sub_f32 v22, v22, v25
    v_add_f32 v23, v23, v24
    v_sub_f32 v24, v8, v30
    v_sub_f32 v25, v9, v31
    v_add_f32 v8, v8, v30
    v_add_f32 v9, v9, v31
    v_add_f32 v30, v16, v27
    v_sub_f32 v31, v17, v26
    v_sub_f32 v16, v16, v27
    v_add_f32 v17, v17, v26
    v_fma_f32 v26, -v22, s26, v18
    v_fma_f32 v27, -v23, s26, v19
    v_fma_f32 v18, v22, s26, v18
    v_fma_f32 v19, v23, s26, v19
    v_fma_f32 v22, v13, s26, v14
    v_fma_f32 v23, -v12, s26, v15
    v_fma_f32 v14, -v13, s26, v14
    v_fma_f32 v15, v12, s26, v15
    v_mul_f32 v10, v8, v46
    v_mul_f32 v11, v8, v47
    v_fma_f32 v8, v9, v47, v10
    v_fma_f32 v9, v9, v46, -v11
    ds_write_b64 v86, v[8:9] offset:0
    v_mul_f32 v28, v18, v48
    v_mul_f32 v29, v18, v49
    v_fma_f32 v18, v19, v49, v28
    v_fma_f32 v19, v19, v48, -v29
    ds_write_b64 v86, v[18:19] offset:64
    v_mul_f32 v10, v16, v50
    v_mul_f32 v11, v16, v51
    v_fma_f32 v16, v17, v51, v10
    v_fma_f32 v17, v17, v50, -v11
    ds_write_b64 v86, v[16:17] offset:128
    v_mul_f32 v28, v14, v52
    v_mul_f32 v29, v14, v53
    v_fma_f32 v14, v15, v53, v28
    v_fma_f32 v15, v15, v52, -v29
    ds_write_b64 v86, v[14:15] offset:192
    v_mul_f32 v10, v24, v54
    v_mul_f32 v11, v24, v55
    v_fma_f32 v24, v25, v55, v10
    v_fma_f32 v25, v25, v54, -v11
    ds_write_b64 v86, v[24:25] offset:256
    v_mul_f32 v28, v26, v56
    v_mul_f32 v29, v26, v57
    v_fma_f32 v26, v27, v57, v28
    v_fma_f32 v27, v27, v56, -v29
    ds_write_b64 v86, v[26:27] offset:320
    v_mul_f32 v10, v30, v58
    v_mul_f32 v11, v30, v59
    v_fma_f32 v30, v31, v59, v10
    v_fma_f32 v31, v31, v58, -v11
    ds_write_b64 v86, v[30:31] offset:384
    v_mul_f32 v28, v22, v60
    v_mul_f32 v29, v22, v61
    v_fma_f32 v22, v23, v61, v28
    v_fma_f32 v23, v23, v60, -v29
    ds_write_b64 v86, v[22:23] offset:448
    ds_read_b64 v[8:9], v87 offset:0
    ds_read_b64 v[18:19], v87 offset:576
    ds_read_b64 v[16:17], v87 offset:1152
    ds_read_b64 v[14:15], v87 offset:1728
    ds_read_b64 v[24:25], v87 offset:2304
    ds_read_b64 v[26:27], v87 offset:2880
    ds_read_b64 v[30:31], v87 offset:3456
    ds_read_b64 v[22:23], v87 offset:4032
    s_waitcnt lgkmcnt(0)
    v_sub_f32 v12, v8, v24
    v_sub_f32 v13, v9, v25
    v_add_f32 v8, v8, v24
    v_add_f32 v9, v9, v25
    v_sub_f32 v24, v18, v26
    v_sub_f32 v25, v19, v27
    v_add_f32 v18, v18, v26
    v_add_f32 v19, v19, v27
    v_sub_f32 v26, v16, v30
    v_sub_f32 v27, v17, v31
    v_add_f32 v16, v16, v30
    v_add_f32 v17, v17, v31
    v_sub_f32 v30, v14, v22
    v_sub_f32 v31, v15, v23
    v_add_f32 v14, v14, v22
    v_add_f32 v15, v15, v23
    v_sub_f32 v22, v24, v25
    v_add_f32 v23, v25, v24
    v_sub_f32 v20, v30, v31
    v_add_f32 v21, v31, v30
    v_sub_f32 v28, v8, v16
    v_sub_f32 v29, v9, v17
    v_add_f32 v8, v8, v16
    v_add_f32 v9, v9, v17
    v_sub_f32 v16, v18, v14
    v_sub_f32 v17, v19, v15
    v_add_f32 v18, v18, v14
    v_add_f32 v19, v19, v15
    v_add_f32 v14, v12, v27
    v_sub_f32 v15, v13, v26
    v_sub_f32 v12, v12, v27
    v_add_f32 v13, v13, v26
    v_add_f32 v26, v22, v21
    v_sub_f32 v27, v23, v20
    v_sub_f32 v22, v22, v21
    v_add_f32 v23, v23, v20
    v_sub_f32 v20, v8, v18
    v_sub_f32 v21, v9, v19
    v_add_f32 v8, v8, v18
    v_add_f32 v9, v9, v19
    v_add_f32 v18, v28, v17
    v_sub_f32 v19, v29, v16
    v_sub_f32 v28, v28, v17
    v_add_f32 v29, v29, v16
    v_fma_f32 v16, -v22, s26, v12
    v_fma_f32 v17, -v23, s26, v13
    v_fma_f32 v12, v22, s26, v12
    v_fma_f32 v13, v23, s26, v13
    v_fma_f32 v22, v27, s26, v14
    v_fma_f32 v23, -v26, s26, v15
    v_fma_f32 v14, -v27, s26, v14
    v_fma_f32 v15, v26, s26, v15
    v_cvt_pk_bf16_f32 v8, v8, v9
    ds_write_b32 v67, v8 offset:0
    v_cvt_pk_bf16_f32 v12, v12, v13
    ds_write_b32 v67, v12 offset:256
    v_cvt_pk_bf16_f32 v28, v28, v29
    ds_write_b32 v67, v28 offset:512
    v_cvt_pk_bf16_f32 v14, v14, v15
    ds_write_b32 v67, v14 offset:768
    v_cvt_pk_bf16_f32 v20, v20, v21
    ds_write_b32 v67, v20 offset:1024
    v_cvt_pk_bf16_f32 v16, v16, v17
    ds_write_b32 v67, v16 offset:1280
    v_cvt_pk_bf16_f32 v18, v18, v19
    ds_write_b32 v67, v18 offset:1536
    v_cvt_pk_bf16_f32 v22, v22, v23
    ds_write_b32 v67, v22 offset:1792
    ds_read_b128 v[100:103], v68
    ds_read_b128 v[104:107], v68 offset:1024
    s_waitcnt lgkmcnt(1)
    v_lshl_or_b32 v108, v100, 16, v136
    v_lshl_or_b32 v109, v101, 16, v137
    v_lshl_or_b32 v110, v102, 16, v136
    v_lshl_or_b32 v111, v103, 16, v137
    buffer_store_dwordx4 v[108:111], v93, s[4:7], s56 offen offset:0 sc1
    v_bfi_b32 v112, s58, v136, v100
    v_bfi_b32 v113, s58, v137, v101
    v_bfi_b32 v114, s58, v136, v102
    v_bfi_b32 v115, s58, v137, v103
    buffer_store_dwordx4 v[112:115], v93, s[4:7], s56 offen offset:2048 sc1
    s_waitcnt lgkmcnt(0)
    v_lshl_or_b32 v116, v104, 16, v136
    v_lshl_or_b32 v117, v105, 16, v137
    v_lshl_or_b32 v118, v106, 16, v136
    v_lshl_or_b32 v119, v107, 16, v137
    buffer_store_dwordx4 v[116:119], v93, s[4:7], s56 offen offset:1024 sc1
    v_bfi_b32 v120, s58, v136, v104
    v_bfi_b32 v121, s58, v137, v105
    v_bfi_b32 v122, s58, v136, v106
    v_bfi_b32 v123, s58, v137, v107
    buffer_store_dwordx4 v[120:123], v93, s[4:7], s56 offen offset:3072 sc1
M_FEND:
    s_endpgm
M_M:
    s_setprio 3
    v_mov_b32 v76, 0
    v_mov_b32 v77, 0
    v_mov_b32 v78, 0
    v_mov_b32 v79, 0
    v_min_u32 v2, 203, v0
    v_lshlrev_b32 v2, 4, v2
    v_add_u32 v2, 34880, v2
    ds_write_b128 v2, v[76:79]
    s_and_b32 s53, s24, 2
    s_lshl_b32 s53, s53, 4
    v_add_u32 v61, 0, v1
    v_mul_u32_u24 v62, 43691, v61
    v_lshrrev_b32 v62, 19, v62
    v_lshlrev_b32 v61, 4, v61
    v_xor_b32 v61, s53, v61
    v_mul_u32_u24 v64, 2560, v62
    v_add_u32 v64, v64, v61
    v_add_u32 v61, 64, v1
    v_mul_u32_u24 v62, 43691, v61
    v_lshrrev_b32 v62, 19, v62
    v_lshlrev_b32 v61, 4, v61
    v_xor_b32 v61, s53, v61
    v_mul_u32_u24 v65, 2560, v62
    v_add_u32 v65, v65, v61
    v_add_u32 v61, 128, v1
    v_mul_u32_u24 v62, 43691, v61
    v_lshrrev_b32 v62, 19, v62
    v_lshlrev_b32 v61, 4, v61
    v_xor_b32 v61, s53, v61
    v_mul_u32_u24 v66, 2560, v62
    v_add_u32 v66, v66, v61
    s_and_b32 s53, s24, 1
    s_mul_i32 s56, s53, 44032
    s_mul_i32 s52, s31, 192
    s_add_u32 s56, s56, s52
    s_mul_i32 s57, s24, 3072
    s_add_u32 s57, s57, 87296
    v_mov_b32 v3, 0
    s_waitcnt lgkmcnt(0)
    s_barrier
    s_cmp_lt_u32 s24, 2
    s_cselect_b32 s64, s40, s42
    s_cselect_b32 s65, s41, s43
    s_mov_b32 s66, 0x158000
    s_mov_b32 s67, 0x00020000
    s_mov_b32 s20, s48
    s_mov_b32 s21, s49
    s_mov_b32 s22, 0x100
    s_mov_b32 s23, 0x00020000
    s_or_b32 s52, s2, s24
    s_cmp_lg_u32 s52, 0
    s_cbranch_scc1 M_NP
    s_memrealtime s[52:53]
    s_waitcnt lgkmcnt(0)
    s_mul_i32 s52, s52, 0x9e3779b1
    s_max_u32 s52, s52, 1
    v_mov_b32 v6, s52
    s_mov_b64 exec, 1
    buffer_store_dword v6, v3, s[20:23], 0 offen sc1
    s_mov_b64 exec, -1
M_NP:
    s_mov_b32 s4, s50
    s_mov_b32 s5, s51
    s_mov_b32 s6, 0x1c00000
    s_mov_b32 s7, 0x00020000
    s_lshl_b32 s52, s24, 8
    s_add_u32 s52, s52, 36032
    v_lshlrev_b32 v7, 2, v1
    v_add_u32 v7, s52, v7
    v_and_b32 v8, 3, v1
    v_mul_u32_u24 v8, 260, v8
    v_add_u32 v8, 35008, v8
    v_bfe_u32 v9, v1, 2, 1
    v_mul_u32_u24 v9, 2064, v9
    v_add_u32 v8, v8, v9
    s_cmp_eq_u32 s31, 15
    s_cbranch_scc1 M_MSP
    s_add_u32 s88, s87, 0
    s_and_b32 s88, s88, 7
    s_mul_i32 s88, s88, 176128
    s_add_u32 s88, s88, s56
    s_add_u32 m0, s57, 0
    s_nop 0
    buffer_load_dwordx4 v64, s[64:67], s88 offen lds
    s_add_u32 m0, s57, 1024
    s_nop 0
    buffer_load_dwordx4 v65, s[64:67], s88 offen lds
    s_add_u32 m0, s57, 2048
    s_nop 0
    buffer_load_dwordx4 v66, s[64:67], s88 offen lds
    s_add_u32 s88, s87, 0
    s_and_b32 s88, s88, 7
    s_mul_i32 s88, s88, 176128
    s_add_u32 s88, s88, s56
    s_add_u32 s88, s88, 88064
    s_add_u32 m0, s57, 12288
    s_nop 0
    buffer_load_dwordx4 v64, s[64:67], s88 offen lds
    s_add_u32 m0, s57, 13312
    s_nop 0
    buffer_load_dwordx4 v65, s[64:67], s88 offen lds
    s_add_u32 m0, s57, 14336
    s_nop 0
    buffer_load_dwordx4 v66, s[64:67], s88 offen lds
    s_lshr_b32 s52, s24, 1
    s_lshl_b32 s52, s52, 13
    s_add_u32 s52, s52, 38144
    v_bfe_u32 v61, v1, 1, 3
    v_lshrrev_b32 v62, 5, v1
    v_xor_b32 v61, v61, v62
    v_lshlrev_b32 v61, 4, v61
    v_and_b32 v62, 31, v1
    v_lshl_add_u32 v61, v62, 7, v61
    v_add_u32 v50, s52, v61
    v_xor_b32 v51, 32, v50
    v_xor_b32 v52, 64, v50
    v_xor_b32 v53, 96, v50
    v_lshrrev_b32 v61, 5, v1
    v_bfe_u32 v62, v1, 2, 2
    v_lshl_add_u32 v61, v61, 3, v62
    v_mul_u32_u24 v61, 192, v61
    v_and_b32 v62, 1, v1
    v_lshl_add_u32 v61, v62, 4, v61
    v_bfe_u32 v62, v1, 1, 1
    v_lshl_add_u32 v61, v62, 3, v61
    v_bfe_u32 v62, v1, 4, 1
    v_mul_u32_u24 v63, 6144, v62
    v_add_u32 v61, v61, v63
    v_add_u32 v61, 87296, v61
    s_and_b32 s52, s24, 1
    s_mul_i32 s52, s52, 3
    s_add_u32 s53, s52, 0
    v_xor_b32 v63, s53, v62
    v_lshl_add_u32 v54, v63, 5, v61
    v_add_u32 v57, 61440, v54
    s_add_u32 s53, s52, 1
    v_xor_b32 v63, s53, v62
    v_lshl_add_u32 v55, v63, 5, v61
    v_add_u32 v58, 61440, v55
    s_add_u32 s53, s52, 2
    v_xor_b32 v63, s53, v62
    v_lshl_add_u32 v56, v63, 5, v61
    v_add_u32 v59, 61440, v56
    s_lshl_b32 s63, s30, 2
    s_and_b32 s53, s24, 2
    s_add_u32 s63, s63, s53
    s_mul_i32 s63, s63, 86
    s_mul_i32 s53, s31, 6
    s_add_u32 s62, s53, s52
    s_add_u32 s63, s63, s62
    s_lshl_b32 s63, s63, 10
    s_add_u32 s63, s63, 12582912
    s_sub_u32 s62, 86, s62
    s_add_u32 s57, s63, 88064
    s_mov_b32 s58, 0xbdd2d3e8
    s_mov_b32 s59, 0xbdd2d3e8
    s_mov_b32 s60, 0x3f800000
    s_mov_b32 s61, 0x3f800000
    v_mov_b32 v4, 0xc0135761
    v_mov_b32 v5, 0xc0135761
    v_lshlrev_b32 v2, 4, v1
    s_waitcnt vmcnt(0)
    v_mov_b32 v9, 99
    ds_write_b32 v7, v9 offset:1024
    s_wakeup
    s_mov_b32 s52, 0
M_MW0_L:
    ds_read_b32 v60, v8 offset:0
    s_add_u32 s52, s52, 1
    s_cmp_ge_u32 s52, 400000
    s_cbranch_scc1 M_MW0_X
    s_waitcnt lgkmcnt(0)
    v_cmp_gt_u32 vcc, 1, v60
    s_cbranch_vccz M_MW0_X
    s_sleep 4
    s_branch M_MW0_L
M_MW0_X:
    s_setprio 3
    ds_read_b128 v[10:13], v50 offset:0
    ds_read_b64_tr_b16 v[26:27], v54 offset:0
    ds_read_b64_tr_b16 v[28:29], v54 offset:768
    ds_read_b128 v[14:17], v50 offset:4096
    ds_read_b64_tr_b16 v[30:31], v55 offset:0
    ds_read_b64_tr_b16 v[32:33], v55 offset:768
    ds_read_b64_tr_b16 v[34:35], v56 offset:0
    ds_read_b64_tr_b16 v[36:37], v56 offset:768
    s_waitcnt lgkmcnt(5)
    v_mfma_f32_32x32x16_bf16 v[64:79], v[26:29], v[10:13], 0
    ds_read_b128 v[18:21], v51 offset:0
    ds_read_b64_tr_b16 v[38:39], v54 offset:3072
    ds_read_b64_tr_b16 v[40:41], v54 offset:3840
    s_waitcnt lgkmcnt(7)
    v_mfma_f32_32x32x16_bf16 v[112:127], v[26:29], v[14:17], 0
    ds_read_b128 v[22:25], v51 offset:4096
    s_waitcnt lgkmcnt(6)
    v_mfma_f32_32x32x16_bf16 v[80:95], v[30:33], v[10:13], 0
    ds_read_b64_tr_b16 v[42:43], v55 offset:3072
    ds_read_b64_tr_b16 v[44:45], v55 offset:3840
    v_mfma_f32_32x32x16_bf16 v[128:143], v[30:33], v[14:17], 0
    ds_read_b64_tr_b16 v[46:47], v56 offset:3072
    ds_read_b64_tr_b16 v[48:49], v56 offset:3840
    v_mov_b32 v9, 1
    ds_write_b32 v7, v9
    s_wakeup
    s_waitcnt lgkmcnt(9)
    v_mfma_f32_32x32x16_bf16 v[96:111], v[34:37], v[10:13], 0
    ds_read_b32 v60, v8
    v_mfma_f32_32x32x16_bf16 v[144:159], v[34:37], v[14:17], 0
    s_waitcnt lgkmcnt(7)
    v_mfma_f32_32x32x16_bf16 v[64:79], v[38:41], v[18:21], v[64:79]
    s_waitcnt lgkmcnt(0)
    v_cmp_gt_u32 vcc, 2, v60
    s_cbranch_vccnz M_MS0
M_MB0:
    ds_read_b128 v[10:13], v52 offset:0
    ds_read_b64_tr_b16 v[26:27], v54 offset:12288
    ds_read_b64_tr_b16 v[28:29], v54 offset:13056
    s_waitcnt lgkmcnt(9)
    v_mfma_f32_32x32x16_bf16 v[112:127], v[38:41], v[22:25], v[112:127]
    ds_read_b128 v[14:17], v52 offset:4096
    s_waitcnt lgkmcnt(8)
    v_mfma_f32_32x32x16_bf16 v[80:95], v[42:45], v[18:21], v[80:95]
    ds_read_b64_tr_b16 v[30:31], v55 offset:12288
    ds_read_b64_tr_b16 v[32:33], v55 offset:13056
    v_mfma_f32_32x32x16_bf16 v[128:143], v[42:45], v[22:25], v[128:143]
    ds_read_b64_tr_b16 v[34:35], v56 offset:12288
    ds_read_b64_tr_b16 v[36:37], v56 offset:13056
    s_waitcnt lgkmcnt(10)
    v_mfma_f32_32x32x16_bf16 v[96:111], v[46:49], v[18:21], v[96:111]
    v_mfma_f32_32x32x16_bf16 v[144:159], v[46:49], v[22:25], v[144:159]
    s_waitcnt lgkmcnt(5)
    v_mfma_f32_32x32x16_bf16 v[64:79], v[26:29], v[10:13], v[64:79]
    ds_read_b128 v[18:21], v53 offset:0
    ds_read_b64_tr_b16 v[38:39], v54 offset:15360
    ds_read_b64_tr_b16 v[40:41], v54 offset:16128
    s_waitcnt lgkmcnt(7)
    v_mfma_f32_32x32x16_bf16 v[112:127], v[26:29], v[14:17], v[112:127]
    ds_read_b128 v[22:25], v53 offset:4096
    s_waitcnt lgkmcnt(6)
    v_mfma_f32_32x32x16_bf16 v[80:95], v[30:33], v[10:13], v[80:95]
    ds_read_b64_tr_b16 v[42:43], v55 offset:15360
    ds_read_b64_tr_b16 v[44:45], v55 offset:16128
    v_mfma_f32_32x32x16_bf16 v[128:143], v[30:33], v[14:17], v[128:143]
    ds_read_b64_tr_b16 v[46:47], v56 offset:15360
    ds_read_b64_tr_b16 v[48:49], v56 offset:16128
    v_mov_b32 v9, 2
    ds_write_b32 v7, v9
    s_wakeup
    s_waitcnt lgkmcnt(9)
    v_mfma_f32_32x32x16_bf16 v[96:111], v[34:37], v[10:13], v[96:111]
    ds_read_b32 v60, v8
    v_mfma_f32_32x32x16_bf16 v[144:159], v[34:37], v[14:17], v[144:159]
    s_waitcnt lgkmcnt(7)
    v_mfma_f32_32x32x16_bf16 v[64:79], v[38:41], v[18:21], v[64:79]
    s_waitcnt lgkmcnt(0)
    v_cmp_gt_u32 vcc, 3, v60
    s_cbranch_vccnz M_MS1
M_MB1:
    ds_read_b128 v[10:13], v50 offset:16384
    ds_read_b64_tr_b16 v[26:27], v54 offset:24576
    ds_read_b64_tr_b16 v[28:29], v54 offset:25344
    s_waitcnt lgkmcnt(9)
    v_mfma_f32_32x32x16_bf16 v[112:127], v[38:41], v[22:25], v[112:127]
    ds_read_b128 v[14:17], v50 offset:20480
    s_waitcnt lgkmcnt(8)
    v_mfma_f32_32x32x16_bf16 v[80:95], v[42:45], v[18:21], v[80:95]
    ds_read_b64_tr_b16 v[30:31], v55 offset:24576
    ds_read_b64_tr_b16 v[32:33], v55 offset:25344
    v_mfma_f32_32x32x16_bf16 v[128:143], v[42:45], v[22:25], v[128:143]
    ds_read_b64_tr_b16 v[34:35], v56 offset:24576
    ds_read_b64_tr_b16 v[36:37], v56 offset:25344
    s_waitcnt lgkmcnt(10)
    v_mfma_f32_32x32x16_bf16 v[96:111], v[46:49], v[18:21], v[96:111]
    v_mfma_f32_32x32x16_bf16 v[144:159], v[46:49], v[22:25], v[144:159]
    s_waitcnt lgkmcnt(5)
    v_mfma_f32_32x32x16_bf16 v[64:79], v[26:29], v[10:13], v[64:79]
    ds_read_b128 v[18:21], v51 offset:16384
    ds_read_b64_tr_b16 v[38:39], v54 offset:27648
    ds_read_b64_tr_b16 v[40:41], v54 offset:28416
    s_waitcnt lgkmcnt(7)
    v_mfma_f32_32x32x16_bf16 v[112:127], v[26:29], v[14:17], v[112:127]
    ds_read_b128 v[22:25], v51 offset:20480
    s_waitcnt lgkmcnt(6)
    v_mfma_f32_32x32x16_bf16 v[80:95], v[30:33], v[10:13], v[80:95]
    ds_read_b64_tr_b16 v[42:43], v55 offset:27648
    ds_read_b64_tr_b16 v[44:45], v55 offset:28416
    v_mfma_f32_32x32x16_bf16 v[128:143], v[30:33], v[14:17], v[128:143]
    ds_read_b64_tr_b16 v[46:47], v56 offset:27648
    ds_read_b64_tr_b16 v[48:49], v56 offset:28416
    v_mov_b32 v9, 3
    ds_write_b32 v7, v9
    s_wakeup
    s_waitcnt lgkmcnt(9)
    v_mfma_f32_32x32x16_bf16 v[96:111], v[34:37], v[10:13], v[96:111]
    ds_read_b32 v60, v8
    v_mfma_f32_32x32x16_bf16 v[144:159], v[34:37], v[14:17], v[144:159]
    s_waitcnt lgkmcnt(7)
    v_mfma_f32_32x32x16_bf16 v[64:79], v[38:41], v[18:21], v[64:79]
    s_waitcnt lgkmcnt(0)
    v_cmp_gt_u32 vcc, 4, v60
    s_cbranch_vccnz M_MS2
M_MB2:
    ds_read_b128 v[10:13], v52 offset:16384
    ds_read_b64_tr_b16 v[26:27], v54 offset:36864
    ds_read_b64_tr_b16 v[28:29], v54 offset:37632
    s_waitcnt lgkmcnt(9)
    v_mfma_f32_32x32x16_bf16 v[112:127], v[38:41], v[22:25], v[112:127]
    ds_read_b128 v[14:17], v52 offset:20480
    s_waitcnt lgkmcnt(8)
    v_mfma_f32_32x32x16_bf16 v[80:95], v[42:45], v[18:21], v[80:95]
    ds_read_b64_tr_b16 v[30:31], v55 offset:36864
    ds_read_b64_tr_b16 v[32:33], v55 offset:37632
    v_mfma_f32_32x32x16_bf16 v[128:143], v[42:45], v[22:25], v[128:143]
    ds_read_b64_tr_b16 v[34:35], v56 offset:36864
    ds_read_b64_tr_b16 v[36:37], v56 offset:37632
    s_waitcnt lgkmcnt(10)
    v_mfma_f32_32x32x16_bf16 v[96:111], v[46:49], v[18:21], v[96:111]
    v_mfma_f32_32x32x16_bf16 v[144:159], v[46:49], v[22:25], v[144:159]
    s_waitcnt lgkmcnt(5)
    v_mfma_f32_32x32x16_bf16 v[64:79], v[26:29], v[10:13], v[64:79]
    ds_read_b128 v[18:21], v53 offset:16384
    ds_read_b64_tr_b16 v[38:39], v54 offset:39936
    ds_read_b64_tr_b16 v[40:41], v54 offset:40704
    s_waitcnt lgkmcnt(7)
    v_mfma_f32_32x32x16_bf16 v[112:127], v[26:29], v[14:17], v[112:127]
    ds_read_b128 v[22:25], v53 offset:20480
    s_waitcnt lgkmcnt(6)
    v_mfma_f32_32x32x16_bf16 v[80:95], v[30:33], v[10:13], v[80:95]
    ds_read_b64_tr_b16 v[42:43], v55 offset:39936
    ds_read_b64_tr_b16 v[44:45], v55 offset:40704
    v_mfma_f32_32x32x16_bf16 v[128:143], v[30:33], v[14:17], v[128:143]
    ds_read_b64_tr_b16 v[46:47], v56 offset:39936
    ds_read_b64_tr_b16 v[48:49], v56 offset:40704
    v_mov_b32 v9, 4
    ds_write_b32 v7, v9
    s_wakeup
    s_waitcnt lgkmcnt(9)
    v_mfma_f32_32x32x16_bf16 v[96:111], v[34:37], v[10:13], v[96:111]
    ds_read_b32 v60, v8
    v_mfma_f32_32x32x16_bf16 v[144:159], v[34:37], v[14:17], v[144:159]
    s_waitcnt lgkmcnt(7)
    v_mfma_f32_32x32x16_bf16 v[64:79], v[38:41], v[18:21], v[64:79]
    s_waitcnt lgkmcnt(0)
    v_cmp_gt_u32 vcc, 5, v60
    s_cbranch_vccnz M_MS3
M_MB3:
    ds_read_b128 v[10:13], v50 offset:32768
    ds_read_b64_tr_b16 v[26:27], v54 offset:49152
    ds_read_b64_tr_b16 v[28:29], v54 offset:49920
    s_waitcnt lgkmcnt(9)
    v_mfma_f32_32x32x16_bf16 v[112:127], v[38:41], v[22:25], v[112:127]
    ds_read_b128 v[14:17], v50 offset:36864
    s_waitcnt lgkmcnt(8)
    v_mfma_f32_32x32x16_bf16 v[80:95], v[42:45], v[18:21], v[80:95]
    ds_read_b64_tr_b16 v[30:31], v55 offset:49152
    ds_read_b64_tr_b16 v[32:33], v55 offset:49920
    v_mfma_f32_32x32x16_bf16 v[128:143], v[42:45], v[22:25], v[128:143]
    ds_read_b64_tr_b16 v[34:35], v56 offset:49152
    ds_read_b64_tr_b16 v[36:37], v56 offset:49920
    s_waitcnt lgkmcnt(10)
    v_mfma_f32_32x32x16_bf16 v[96:111], v[46:49], v[18:21], v[96:111]
    v_mfma_f32_32x32x16_bf16 v[144:159], v[46:49], v[22:25], v[144:159]
    s_waitcnt lgkmcnt(5)
    v_mfma_f32_32x32x16_bf16 v[64:79], v[26:29], v[10:13], v[64:79]
    ds_read_b128 v[18:21], v51 offset:32768
    ds_read_b64_tr_b16 v[38:39], v54 offset:52224
    ds_read_b64_tr_b16 v[40:41], v54 offset:52992
    s_waitcnt lgkmcnt(7)
    v_mfma_f32_32x32x16_bf16 v[112:127], v[26:29], v[14:17], v[112:127]
    ds_read_b128 v[22:25], v51 offset:36864
    s_waitcnt lgkmcnt(6)
    v_mfma_f32_32x32x16_bf16 v[80:95], v[30:33], v[10:13], v[80:95]
    ds_read_b64_tr_b16 v[42:43], v55 offset:52224
    ds_read_b64_tr_b16 v[44:45], v55 offset:52992
    v_mfma_f32_32x32x16_bf16 v[128:143], v[30:33], v[14:17], v[128:143]
    ds_read_b64_tr_b16 v[46:47], v56 offset:52224
    ds_read_b64_tr_b16 v[48:49], v56 offset:52992
    v_mov_b32 v9, 5
    ds_write_b32 v7, v9
    s_wakeup
    s_waitcnt lgkmcnt(9)
    v_mfma_f32_32x32x16_bf16 v[96:111], v[34:37], v[10:13], v[96:111]
    ds_read_b32 v60, v8
    v_mfma_f32_32x32x16_bf16 v[144:159], v[34:37], v[14:17], v[144:159]
    s_waitcnt lgkmcnt(7)
    v_mfma_f32_32x32x16_bf16 v[64:79], v[38:41], v[18:21], v[64:79]
    s_waitcnt lgkmcnt(0)
    v_cmp_gt_u32 vcc, 6, v60
    s_cbranch_vccnz M_MS4
M_MB4:
    ds_read_b128 v[10:13], v52 offset:32768
    ds_read_b64_tr_b16 v[26:27], v57 offset:0
    ds_read_b64_tr_b16 v[28:29], v57 offset:768
    s_waitcnt lgkmcnt(9)
    v_mfma_f32_32x32x16_bf16 v[112:127], v[38:41], v[22:25], v[112:127]
    ds_read_b128 v[14:17], v52 offset:36864
    s_waitcnt lgkmcnt(8)
    v_mfma_f32_32x32x16_bf16 v[80:95], v[42:45], v[18:21], v[80:95]
    ds_read_b64_tr_b16 v[30:31], v58 offset:0
    ds_read_b64_tr_b16 v[32:33], v58 offset:768
    v_mfma_f32_32x32x16_bf16 v[128:143], v[42:45], v[22:25], v[128:143]
    ds_read_b64_tr_b16 v[34:35], v59 offset:0
    ds_read_b64_tr_b16 v[36:37], v59 offset:768
    s_waitcnt lgkmcnt(10)
    v_mfma_f32_32x32x16_bf16 v[96:111], v[46:49], v[18:21], v[96:111]
    v_mfma_f32_32x32x16_bf16 v[144:159], v[46:49], v[22:25], v[144:159]
    s_waitcnt lgkmcnt(5)
    v_mfma_f32_32x32x16_bf16 v[64:79], v[26:29], v[10:13], v[64:79]
    ds_read_b128 v[18:21], v53 offset:32768
    ds_read_b64_tr_b16 v[38:39], v57 offset:3072
    ds_read_b64_tr_b16 v[40:41], v57 offset:3840
    s_waitcnt lgkmcnt(7)
    v_mfma_f32_32x32x16_bf16 v[112:127], v[26:29], v[14:17], v[112:127]
    ds_read_b128 v[22:25], v53 offset:36864
    s_waitcnt lgkmcnt(6)
    v_mfma_f32_32x32x16_bf16 v[80:95], v[30:33], v[10:13], v[80:95]
    ds_read_b64_tr_b16 v[42:43], v58 offset:3072
    ds_read_b64_tr_b16 v[44:45], v58 offset:3840
    v_mfma_f32_32x32x16_bf16 v[128:143], v[30:33], v[14:17], v[128:143]
    ds_read_b64_tr_b16 v[46:47], v59 offset:3072
    ds_read_b64_tr_b16 v[48:49], v59 offset:3840
    v_mov_b32 v9, 6
    ds_write_b32 v7, v9
    s_wakeup
    s_waitcnt lgkmcnt(9)
    v_mfma_f32_32x32x16_bf16 v[96:111], v[34:37], v[10:13], v[96:111]
    ds_read_b32 v60, v8
    v_mfma_f32_32x32x16_bf16 v[144:159], v[34:37], v[14:17], v[144:159]
    s_waitcnt lgkmcnt(7)
    v_mfma_f32_32x32x16_bf16 v[64:79], v[38:41], v[18:21], v[64:79]
    s_waitcnt lgkmcnt(0)
    v_cmp_gt_u32 vcc, 7, v60
    s_cbranch_vccnz M_MS5
M_MB5:
    ds_read_b128 v[10:13], v50 offset:0
    ds_read_b64_tr_b16 v[26:27], v54 offset:0
    ds_read_b64_tr_b16 v[28:29], v54 offset:768
    s_waitcnt lgkmcnt(9)
    v_mfma_f32_32x32x16_bf16 v[112:127], v[38:41], v[22:25], v[112:127]
    ds_read_b128 v[14:17], v50 offset:4096
    s_waitcnt lgkmcnt(8)
    v_mfma_f32_32x32x16_bf16 v[80:95], v[42:45], v[18:21], v[80:95]
    ds_read_b64_tr_b16 v[30:31], v55 offset:0
    ds_read_b64_tr_b16 v[32:33], v55 offset:768
    v_mfma_f32_32x32x16_bf16 v[128:143], v[42:45], v[22:25], v[128:143]
    ds_read_b64_tr_b16 v[34:35], v56 offset:0
    ds_read_b64_tr_b16 v[36:37], v56 offset:768
    s_waitcnt lgkmcnt(10)
    v_mfma_f32_32x32x16_bf16 v[96:111], v[46:49], v[18:21], v[96:111]
    v_mfma_f32_32x32x16_bf16 v[144:159], v[46:49], v[22:25], v[144:159]
    s_waitcnt lgkmcnt(5)
    v_mfma_f32_32x32x16_bf16 v[64:79], v[26:29], v[10:13], v[64:79]
    ds_read_b128 v[18:21], v51 offset:0
    ds_read_b64_tr_b16 v[38:39], v54 offset:3072
    ds_read_b64_tr_b16 v[40:41], v54 offset:3840
    s_waitcnt lgkmcnt(7)
    v_mfma_f32_32x32x16_bf16 v[112:127], v[26:29], v[14:17], v[112:127]
    ds_read_b128 v[22:25], v51 offset:4096
    s_waitcnt lgkmcnt(6)
    v_mfma_f32_32x32x16_bf16 v[80:95], v[30:33], v[10:13], v[80:95]
    ds_read_b64_tr_b16 v[42:43], v55 offset:3072
    ds_read_b64_tr_b16 v[44:45], v55 offset:3840
    v_mfma_f32_32x32x16_bf16 v[128:143], v[30:33], v[14:17], v[128:143]
    ds_read_b64_tr_b16 v[46:47], v56 offset:3072
    ds_read_b64_tr_b16 v[48:49], v56 offset:3840
    v_mov_b32 v9, 7
    ds_write_b32 v7, v9
    s_wakeup
    s_waitcnt lgkmcnt(9)
    v_mfma_f32_32x32x16_bf16 v[96:111], v[34:37], v[10:13], v[96:111]
    ds_read_b32 v60, v8
    v_mfma_f32_32x32x16_bf16 v[144:159], v[34:37], v[14:17], v[144:159]
    s_waitcnt lgkmcnt(7)
    v_mfma_f32_32x32x16_bf16 v[64:79], v[38:41], v[18:21], v[64:79]
    s_waitcnt lgkmcnt(0)
    v_cmp_gt_u32 vcc, 8, v60
    s_cbranch_vccnz M_MS6
M_MB6:
    ds_read_b128 v[10:13], v52 offset:0
    ds_read_b64_tr_b16 v[26:27], v54 offset:12288
    ds_read_b64_tr_b16 v[28:29], v54 offset:13056
    s_waitcnt lgkmcnt(9)
    v_mfma_f32_32x32x16_bf16 v[112:127], v[38:41], v[22:25], v[112:127]
    ds_read_b128 v[14:17], v52 offset:4096
    s_waitcnt lgkmcnt(8)
    v_mfma_f32_32x32x16_bf16 v[80:95], v[42:45], v[18:21], v[80:95]
    ds_read_b64_tr_b16 v[30:31], v55 offset:12288
    ds_read_b64_tr_b16 v[32:33], v55 offset:13056
    v_mfma_f32_32x32x16_bf16 v[128:143], v[42:45], v[22:25], v[128:143]
    ds_read_b64_tr_b16 v[34:35], v56 offset:12288
    ds_read_b64_tr_b16 v[36:37], v56 offset:13056
    s_waitcnt lgkmcnt(10)
    v_mfma_f32_32x32x16_bf16 v[96:111], v[46:49], v[18:21], v[96:111]
    v_mfma_f32_32x32x16_bf16 v[144:159], v[46:49], v[22:25], v[144:159]
    s_waitcnt lgkmcnt(5)
    v_mfma_f32_32x32x16_bf16 v[64:79], v[26:29], v[10:13], v[64:79]
    ds_read_b128 v[18:21], v53 offset:0
    ds_read_b64_tr_b16 v[38:39], v54 offset:15360
    ds_read_b64_tr_b16 v[40:41], v54 offset:16128
    s_waitcnt lgkmcnt(7)
    v_mfma_f32_32x32x16_bf16 v[112:127], v[26:29], v[14:17], v[112:127]
    ds_read_b128 v[22:25], v53 offset:4096
    s_waitcnt lgkmcnt(6)
    v_mfma_f32_32x32x16_bf16 v[80:95], v[30:33], v[10:13], v[80:95]
    ds_read_b64_tr_b16 v[42:43], v55 offset:15360
    ds_read_b64_tr_b16 v[44:45], v55 offset:16128
    v_mfma_f32_32x32x16_bf16 v[128:143], v[30:33], v[14:17], v[128:143]
    ds_read_b64_tr_b16 v[46:47], v56 offset:15360
    ds_read_b64_tr_b16 v[48:49], v56 offset:16128
    v_mov_b32 v9, 8
    ds_write_b32 v7, v9
    s_wakeup
    s_waitcnt lgkmcnt(9)
    v_mfma_f32_32x32x16_bf16 v[96:111], v[34:37], v[10:13], v[96:111]
    ds_read_b32 v60, v8
    v_mfma_f32_32x32x16_bf16 v[144:159], v[34:37], v[14:17], v[144:159]
    s_waitcnt lgkmcnt(7)
    v_mfma_f32_32x32x16_bf16 v[64:79], v[38:41], v[18:21], v[64:79]
    s_waitcnt lgkmcnt(0)
    v_cmp_gt_u32 vcc, 9, v60
    s_cbranch_vccnz M_MS7
M_MB7:
    ds_read_b128 v[10:13], v50 offset:16384
    ds_read_b64_tr_b16 v[26:27], v54 offset:24576
    ds_read_b64_tr_b16 v[28:29], v54 offset:25344
    s_waitcnt lgkmcnt(9)
    v_mfma_f32_32x32x16_bf16 v[112:127], v[38:41], v[22:25], v[112:127]
    ds_read_b128 v[14:17], v50 offset:20480
    s_waitcnt lgkmcnt(8)
    v_mfma_f32_32x32x16_bf16 v[80:95], v[42:45], v[18:21], v[80:95]
    ds_read_b64_tr_b16 v[30:31], v55 offset:24576
    ds_read_b64_tr_b16 v[32:33], v55 offset:25344
    v_mfma_f32_32x32x16_bf16 v[128:143], v[42:45], v[22:25], v[128:143]
    ds_read_b64_tr_b16 v[34:35], v56 offset:24576
    ds_read_b64_tr_b16 v[36:37], v56 offset:25344
    s_waitcnt lgkmcnt(10)
    v_mfma_f32_32x32x16_bf16 v[96:111], v[46:49], v[18:21], v[96:111]
    v_mfma_f32_32x32x16_bf16 v[144:159], v[46:49], v[22:25], v[144:159]
    s_waitcnt lgkmcnt(5)
    v_mfma_f32_32x32x16_bf16 v[64:79], v[26:29], v[10:13], v[64:79]
    ds_read_b128 v[18:21], v51 offset:16384
    ds_read_b64_tr_b16 v[38:39], v54 offset:27648
    ds_read_b64_tr_b16 v[40:41], v54 offset:28416
    s_waitcnt lgkmcnt(7)
    v_mfma_f32_32x32x16_bf16 v[112:127], v[26:29], v[14:17], v[112:127]
    ds_read_b128 v[22:25], v51 offset:20480
    s_waitcnt lgkmcnt(6)
    v_mfma_f32_32x32x16_bf16 v[80:95], v[30:33], v[10:13], v[80:95]
    ds_read_b64_tr_b16 v[42:43], v55 offset:27648
    ds_read_b64_tr_b16 v[44:45], v55 offset:28416
    v_mfma_f32_32x32x16_bf16 v[128:143], v[30:33], v[14:17], v[128:143]
    ds_read_b64_tr_b16 v[46:47], v56 offset:27648
    ds_read_b64_tr_b16 v[48:49], v56 offset:28416
    v_mov_b32 v9, 9
    ds_write_b32 v7, v9
    s_wakeup
    s_waitcnt lgkmcnt(9)
    v_mfma_f32_32x32x16_bf16 v[96:111], v[34:37], v[10:13], v[96:111]
    ds_read_b32 v60, v8
    v_mfma_f32_32x32x16_bf16 v[144:159], v[34:37], v[14:17], v[144:159]
    s_waitcnt lgkmcnt(7)
    v_mfma_f32_32x32x16_bf16 v[64:79], v[38:41], v[18:21], v[64:79]
    s_waitcnt lgkmcnt(0)
    v_cmp_gt_u32 vcc, 10, v60
    s_cbranch_vccnz M_MS8
M_MB8:
    ds_read_b128 v[10:13], v52 offset:16384
    ds_read_b64_tr_b16 v[26:27], v54 offset:36864
    ds_read_b64_tr_b16 v[28:29], v54 offset:37632
    s_waitcnt lgkmcnt(9)
    v_mfma_f32_32x32x16_bf16 v[112:127], v[38:41], v[22:25], v[112:127]
    ds_read_b128 v[14:17], v52 offset:20480
    s_waitcnt lgkmcnt(8)
    v_mfma_f32_32x32x16_bf16 v[80:95], v[42:45], v[18:21], v[80:95]
    ds_read_b64_tr_b16 v[30:31], v55 offset:36864
    ds_read_b64_tr_b16 v[32:33], v55 offset:37632
    v_mfma_f32_32x32x16_bf16 v[128:143], v[42:45], v[22:25], v[128:143]
    ds_read_b64_tr_b16 v[34:35], v56 offset:36864
    ds_read_b64_tr_b16 v[36:37], v56 offset:37632
    s_waitcnt lgkmcnt(10)
    v_mfma_f32_32x32x16_bf16 v[96:111], v[46:49], v[18:21], v[96:111]
    v_mfma_f32_32x32x16_bf16 v[144:159], v[46:49], v[22:25], v[144:159]
    s_waitcnt lgkmcnt(5)
    v_mfma_f32_32x32x16_bf16 v[64:79], v[26:29], v[10:13], v[64:79]
    ds_read_b128 v[18:21], v53 offset:16384
    ds_read_b64_tr_b16 v[38:39], v54 offset:39936
    ds_read_b64_tr_b16 v[40:41], v54 offset:40704
    s_waitcnt lgkmcnt(7)
    v_mfma_f32_32x32x16_bf16 v[112:127], v[26:29], v[14:17], v[112:127]
    ds_read_b128 v[22:25], v53 offset:20480
    s_waitcnt lgkmcnt(6)
    v_mfma_f32_32x32x16_bf16 v[80:95], v[30:33], v[10:13], v[80:95]
    ds_read_b64_tr_b16 v[42:43], v55 offset:39936
    ds_read_b64_tr_b16 v[44:45], v55 offset:40704
    v_mfma_f32_32x32x16_bf16 v[128:143], v[30:33], v[14:17], v[128:143]
    ds_read_b64_tr_b16 v[46:47], v56 offset:39936
    ds_read_b64_tr_b16 v[48:49], v56 offset:40704
    v_mov_b32 v9, 10
    ds_write_b32 v7, v9
    s_wakeup
    s_waitcnt lgkmcnt(9)
    v_mfma_f32_32x32x16_bf16 v[96:111], v[34:37], v[10:13], v[96:111]
    ds_read_b32 v60, v8
    v_mfma_f32_32x32x16_bf16 v[144:159], v[34:37], v[14:17], v[144:159]
    s_waitcnt lgkmcnt(7)
    v_mfma_f32_32x32x16_bf16 v[64:79], v[38:41], v[18:21], v[64:79]
    s_waitcnt lgkmcnt(0)
    v_cmp_gt_u32 vcc, 11, v60
    s_cbranch_vccnz M_MS9
M_MB9:
    ds_read_b128 v[10:13], v50 offset:32768
    ds_read_b64_tr_b16 v[26:27], v54 offset:49152
    ds_read_b64_tr_b16 v[28:29], v54 offset:49920
    s_waitcnt lgkmcnt(9)
    v_mfma_f32_32x32x16_bf16 v[112:127], v[38:41], v[22:25], v[112:127]
    ds_read_b128 v[14:17], v50 offset:36864
    s_waitcnt lgkmcnt(8)
    v_mfma_f32_32x32x16_bf16 v[80:95], v[42:45], v[18:21], v[80:95]
    ds_read_b64_tr_b16 v[30:31], v55 offset:49152
    ds_read_b64_tr_b16 v[32:33], v55 offset:49920
    v_mfma_f32_32x32x16_bf16 v[128:143], v[42:45], v[22:25], v[128:143]
    ds_read_b64_tr_b16 v[34:35], v56 offset:49152
    ds_read_b64_tr_b16 v[36:37], v56 offset:49920
    s_waitcnt lgkmcnt(10)
    v_mfma_f32_32x32x16_bf16 v[96:111], v[46:49], v[18:21], v[96:111]
    v_mfma_f32_32x32x16_bf16 v[144:159], v[46:49], v[22:25], v[144:159]
    s_waitcnt lgkmcnt(5)
    v_mfma_f32_32x32x16_bf16 v[64:79], v[26:29], v[10:13], v[64:79]
    ds_read_b128 v[18:21], v51 offset:32768
    ds_read_b64_tr_b16 v[38:39], v54 offset:52224
    ds_read_b64_tr_b16 v[40:41], v54 offset:52992
    s_waitcnt lgkmcnt(7)
    v_mfma_f32_32x32x16_bf16 v[112:127], v[26:29], v[14:17], v[112:127]
    ds_read_b128 v[22:25], v51 offset:36864
    s_waitcnt lgkmcnt(6)
    v_mfma_f32_32x32x16_bf16 v[80:95], v[30:33], v[10:13], v[80:95]
    ds_read_b64_tr_b16 v[42:43], v55 offset:52224
    ds_read_b64_tr_b16 v[44:45], v55 offset:52992
    v_mfma_f32_32x32x16_bf16 v[128:143], v[30:33], v[14:17], v[128:143]
    ds_read_b64_tr_b16 v[46:47], v56 offset:52224
    ds_read_b64_tr_b16 v[48:49], v56 offset:52992
    v_mov_b32 v9, 11
    ds_write_b32 v7, v9
    s_wakeup
    s_waitcnt lgkmcnt(9)
    v_mfma_f32_32x32x16_bf16 v[96:111], v[34:37], v[10:13], v[96:111]
    ds_read_b32 v60, v8
    v_mfma_f32_32x32x16_bf16 v[144:159], v[34:37], v[14:17], v[144:159]
    s_waitcnt lgkmcnt(7)
    v_mfma_f32_32x32x16_bf16 v[64:79], v[38:41], v[18:21], v[64:79]
    s_waitcnt lgkmcnt(0)
    v_cmp_gt_u32 vcc, 12, v60
    s_cbranch_vccnz M_MS10
M_MB10:
    ds_read_b128 v[10:13], v52 offset:32768
    ds_read_b64_tr_b16 v[26:27], v57 offset:0
    ds_read_b64_tr_b16 v[28:29], v57 offset:768
    s_waitcnt lgkmcnt(9)
    v_mfma_f32_32x32x16_bf16 v[112:127], v[38:41], v[22:25], v[112:127]
    ds_read_b128 v[14:17], v52 offset:36864
    s_waitcnt lgkmcnt(8)
    v_mfma_f32_32x32x16_bf16 v[80:95], v[42:45], v[18:21], v[80:95]
    ds_read_b64_tr_b16 v[30:31], v58 offset:0
    ds_read_b64_tr_b16 v[32:33], v58 offset:768
    v_mfma_f32_32x32x16_bf16 v[128:143], v[42:45], v[22:25], v[128:143]
    ds_read_b64_tr_b16 v[34:35], v59 offset:0
    ds_read_b64_tr_b16 v[36:37], v59 offset:768
    s_waitcnt lgkmcnt(10)
    v_mfma_f32_32x32x16_bf16 v[96:111], v[46:49], v[18:21], v[96:111]
    v_mfma_f32_32x32x16_bf16 v[144:159], v[46:49], v[22:25], v[144:159]
    s_waitcnt lgkmcnt(5)
    v_mfma_f32_32x32x16_bf16 v[64:79], v[26:29], v[10:13], v[64:79]
    ds_read_b128 v[18:21], v53 offset:32768
    ds_read_b64_tr_b16 v[38:39], v57 offset:3072
    ds_read_b64_tr_b16 v[40:41], v57 offset:3840
    s_waitcnt lgkmcnt(7)
    v_mfma_f32_32x32x16_bf16 v[112:127], v[26:29], v[14:17], v[112:127]
    ds_read_b128 v[22:25], v53 offset:36864
    s_waitcnt lgkmcnt(6)
    v_mfma_f32_32x32x16_bf16 v[80:95], v[30:33], v[10:13], v[80:95]
    ds_read_b64_tr_b16 v[42:43], v58 offset:3072
    ds_read_b64_tr_b16 v[44:45], v58 offset:3840
    v_mfma_f32_32x32x16_bf16 v[128:143], v[30:33], v[14:17], v[128:143]
    ds_read_b64_tr_b16 v[46:47], v59 offset:3072
    ds_read_b64_tr_b16 v[48:49], v59 offset:3840
    v_mov_b32 v9, 12
    ds_write_b32 v7, v9
    s_wakeup
    s_waitcnt lgkmcnt(9)
    v_mfma_f32_32x32x16_bf16 v[96:111], v[34:37], v[10:13], v[96:111]
    ds_read_b32 v60, v8
    v_mfma_f32_32x32x16_bf16 v[144:159], v[34:37], v[14:17], v[144:159]
    s_waitcnt lgkmcnt(7)
    v_mfma_f32_32x32x16_bf16 v[64:79], v[38:41], v[18:21], v[64:79]
    s_waitcnt lgkmcnt(0)
    v_cmp_gt_u32 vcc, 13, v60
    s_cbranch_vccnz M_MS11
M_MB11:
    ds_read_b128 v[10:13], v50 offset:0
    ds_read_b64_tr_b16 v[26:27], v54 offset:0
    ds_read_b64_tr_b16 v[28:29], v54 offset:768
    s_waitcnt lgkmcnt(9)
    v_mfma_f32_32x32x16_bf16 v[112:127], v[38:41], v[22:25], v[112:127]
    ds_read_b128 v[14:17], v50 offset:4096
    s_waitcnt lgkmcnt(8)
    v_mfma_f32_32x32x16_bf16 v[80:95], v[42:45], v[18:21], v[80:95]
    ds_read_b64_tr_b16 v[30:31], v55 offset:0
    ds_read_b64_tr_b16 v[32:33], v55 offset:768
    v_mfma_f32_32x32x16_bf16 v[128:143], v[42:45], v[22:25], v[128:143]
    ds_read_b64_tr_b16 v[34:35], v56 offset:0
    ds_read_b64_tr_b16 v[36:37], v56 offset:768
    s_waitcnt lgkmcnt(10)
    v_mfma_f32_32x32x16_bf16 v[96:111], v[46:49], v[18:21], v[96:111]
    v_mfma_f32_32x32x16_bf16 v[144:159], v[46:49], v[22:25], v[144:159]
    s_waitcnt lgkmcnt(5)
    v_mfma_f32_32x32x16_bf16 v[64:79], v[26:29], v[10:13], v[64:79]
    ds_read_b128 v[18:21], v51 offset:0
    ds_read_b64_tr_b16 v[38:39], v54 offset:3072
    ds_read_b64_tr_b16 v[40:41], v54 offset:3840
    s_waitcnt lgkmcnt(7)
    v_mfma_f32_32x32x16_bf16 v[112:127], v[26:29], v[14:17], v[112:127]
    ds_read_b128 v[22:25], v51 offset:4096
    s_waitcnt lgkmcnt(6)
    v_mfma_f32_32x32x16_bf16 v[80:95], v[30:33], v[10:13], v[80:95]
    ds_read_b64_tr_b16 v[42:43], v55 offset:3072
    ds_read_b64_tr_b16 v[44:45], v55 offset:3840
    v_mfma_f32_32x32x16_bf16 v[128:143], v[30:33], v[14:17], v[128:143]
    ds_read_b64_tr_b16 v[46:47], v56 offset:3072
    ds_read_b64_tr_b16 v[48:49], v56 offset:3840
    v_mov_b32 v9, 13
    ds_write_b32 v7, v9
    s_wakeup
    s_waitcnt lgkmcnt(9)
    v_mfma_f32_32x32x16_bf16 v[96:111], v[34:37], v[10:13], v[96:111]
    ds_read_b32 v60, v8
    v_mfma_f32_32x32x16_bf16 v[144:159], v[34:37], v[14:17], v[144:159]
    s_waitcnt lgkmcnt(7)
    v_mfma_f32_32x32x16_bf16 v[64:79], v[38:41], v[18:21], v[64:79]
    s_waitcnt lgkmcnt(0)
    v_cmp_gt_u32 vcc, 14, v60
    s_cbranch_vccnz M_MS12
M_MB12:
    ds_read_b128 v[10:13], v52 offset:0
    ds_read_b64_tr_b16 v[26:27], v54 offset:12288
    ds_read_b64_tr_b16 v[28:29], v54 offset:13056
    s_waitcnt lgkmcnt(9)
    v_mfma_f32_32x32x16_bf16 v[112:127], v[38:41], v[22:25], v[112:127]
    ds_read_b128 v[14:17], v52 offset:4096
    s_waitcnt lgkmcnt(8)
    v_mfma_f32_32x32x16_bf16 v[80:95], v[42:45], v[18:21], v[80:95]
    ds_read_b64_tr_b16 v[30:31], v55 offset:12288
    ds_read_b64_tr_b16 v[32:33], v55 offset:13056
    v_mfma_f32_32x32x16_bf16 v[128:143], v[42:45], v[22:25], v[128:143]
    ds_read_b64_tr_b16 v[34:35], v56 offset:12288
    ds_read_b64_tr_b16 v[36:37], v56 offset:13056
    s_waitcnt lgkmcnt(10)
    v_mfma_f32_32x32x16_bf16 v[96:111], v[46:49], v[18:21], v[96:111]
    v_mfma_f32_32x32x16_bf16 v[144:159], v[46:49], v[22:25], v[144:159]
    s_waitcnt lgkmcnt(5)
    v_mfma_f32_32x32x16_bf16 v[64:79], v[26:29], v[10:13], v[64:79]
    ds_read_b128 v[18:21], v53 offset:0
    ds_read_b64_tr_b16 v[38:39], v54 offset:15360
    ds_read_b64_tr_b16 v[40:41], v54 offset:16128
    s_waitcnt lgkmcnt(7)
    v_mfma_f32_32x32x16_bf16 v[112:127], v[26:29], v[14:17], v[112:127]
    ds_read_b128 v[22:25], v53 offset:4096
    s_waitcnt lgkmcnt(6)
    v_mfma_f32_32x32x16_bf16 v[80:95], v[30:33], v[10:13], v[80:95]
    ds_read_b64_tr_b16 v[42:43], v55 offset:15360
    ds_read_b64_tr_b16 v[44:45], v55 offset:16128
    v_mfma_f32_32x32x16_bf16 v[128:143], v[30:33], v[14:17], v[128:143]
    ds_read_b64_tr_b16 v[46:47], v56 offset:15360
    ds_read_b64_tr_b16 v[48:49], v56 offset:16128
    v_mov_b32 v9, 14
    ds_write_b32 v7, v9
    s_wakeup
    s_waitcnt lgkmcnt(9)
    v_mfma_f32_32x32x16_bf16 v[96:111], v[34:37], v[10:13], v[96:111]
    ds_read_b32 v60, v8
    v_mfma_f32_32x32x16_bf16 v[144:159], v[34:37], v[14:17], v[144:159]
    s_waitcnt lgkmcnt(7)
    v_mfma_f32_32x32x16_bf16 v[64:79], v[38:41], v[18:21], v[64:79]
    s_waitcnt lgkmcnt(0)
    v_cmp_gt_u32 vcc, 15, v60
    s_cbranch_vccnz M_MS13
M_MB13:
    ds_read_b128 v[10:13], v50 offset:16384
    ds_read_b64_tr_b16 v[26:27], v54 offset:24576
    ds_read_b64_tr_b16 v[28:29], v54 offset:25344
    s_waitcnt lgkmcnt(9)
    v_mfma_f32_32x32x16_bf16 v[112:127], v[38:41], v[22:25], v[112:127]
    ds_read_b128 v[14:17], v50 offset:20480
    s_waitcnt lgkmcnt(8)
    v_mfma_f32_32x32x16_bf16 v[80:95], v[42:45], v[18:21], v[80:95]
    ds_read_b64_tr_b16 v[30:31], v55 offset:24576
    ds_read_b64_tr_b16 v[32:33], v55 offset:25344
    v_mfma_f32_32x32x16_bf16 v[128:143], v[42:45], v[22:25], v[128:143]
    ds_read_b64_tr_b16 v[34:35], v56 offset:24576
    ds_read_b64_tr_b16 v[36:37], v56 offset:25344
    s_waitcnt lgkmcnt(10)
    v_mfma_f32_32x32x16_bf16 v[96:111], v[46:49], v[18:21], v[96:111]
    v_mfma_f32_32x32x16_bf16 v[144:159], v[46:49], v[22:25], v[144:159]
    s_waitcnt lgkmcnt(5)
    v_mfma_f32_32x32x16_bf16 v[64:79], v[26:29], v[10:13], v[64:79]
    ds_read_b128 v[18:21], v51 offset:16384
    ds_read_b64_tr_b16 v[38:39], v54 offset:27648
    ds_read_b64_tr_b16 v[40:41], v54 offset:28416
    s_waitcnt lgkmcnt(7)
    v_mfma_f32_32x32x16_bf16 v[112:127], v[26:29], v[14:17], v[112:127]
    ds_read_b128 v[22:25], v51 offset:20480
    s_waitcnt lgkmcnt(6)
    v_mfma_f32_32x32x16_bf16 v[80:95], v[30:33], v[10:13], v[80:95]
    ds_read_b64_tr_b16 v[42:43], v55 offset:27648
    ds_read_b64_tr_b16 v[44:45], v55 offset:28416
    v_mfma_f32_32x32x16_bf16 v[128:143], v[30:33], v[14:17], v[128:143]
    ds_read_b64_tr_b16 v[46:47], v56 offset:27648
    ds_read_b64_tr_b16 v[48:49], v56 offset:28416
    v_mov_b32 v9, 15
    ds_write_b32 v7, v9
    s_wakeup
    s_waitcnt lgkmcnt(9)
    v_mfma_f32_32x32x16_bf16 v[96:111], v[34:37], v[10:13], v[96:111]
    ds_read_b32 v60, v8
    v_mfma_f32_32x32x16_bf16 v[144:159], v[34:37], v[14:17], v[144:159]
    s_waitcnt lgkmcnt(7)
    v_mfma_f32_32x32x16_bf16 v[64:79], v[38:41], v[18:21], v[64:79]
    s_waitcnt lgkmcnt(0)
    v_cmp_gt_u32 vcc, 16, v60
    s_cbranch_vccnz M_MS14
M_MB14:
    ds_read_b128 v[10:13], v52 offset:16384
    ds_read_b64_tr_b16 v[26:27], v54 offset:36864
    ds_read_b64_tr_b16 v[28:29], v54 offset:37632
    s_waitcnt lgkmcnt(9)
    v_mfma_f32_32x32x16_bf16 v[112:127], v[38:41], v[22:25], v[112:127]
    ds_read_b128 v[14:17], v52 offset:20480
    s_waitcnt lgkmcnt(8)
    v_mfma_f32_32x32x16_bf16 v[80:95], v[42:45], v[18:21], v[80:95]
    ds_read_b64_tr_b16 v[30:31], v55 offset:36864
    ds_read_b64_tr_b16 v[32:33], v55 offset:37632
    v_mfma_f32_32x32x16_bf16 v[128:143], v[42:45], v[22:25], v[128:143]
    ds_read_b64_tr_b16 v[34:35], v56 offset:36864
    ds_read_b64_tr_b16 v[36:37], v56 offset:37632
    s_waitcnt lgkmcnt(10)
    v_mfma_f32_32x32x16_bf16 v[96:111], v[46:49], v[18:21], v[96:111]
    v_mfma_f32_32x32x16_bf16 v[144:159], v[46:49], v[22:25], v[144:159]
    s_waitcnt lgkmcnt(5)
    v_mfma_f32_32x32x16_bf16 v[64:79], v[26:29], v[10:13], v[64:79]
    ds_read_b128 v[18:21], v53 offset:16384
    ds_read_b64_tr_b16 v[38:39], v54 offset:39936
    ds_read_b64_tr_b16 v[40:41], v54 offset:40704
    s_waitcnt lgkmcnt(7)
    v_mfma_f32_32x32x16_bf16 v[112:127], v[26:29], v[14:17], v[112:127]
    ds_read_b128 v[22:25], v53 offset:20480
    s_waitcnt lgkmcnt(6)
    v_mfma_f32_32x32x16_bf16 v[80:95], v[30:33], v[10:13], v[80:95]
    ds_read_b64_tr_b16 v[42:43], v55 offset:39936
    ds_read_b64_tr_b16 v[44:45], v55 offset:40704
    v_mfma_f32_32x32x16_bf16 v[128:143], v[30:33], v[14:17], v[128:143]
    ds_read_b64_tr_b16 v[46:47], v56 offset:39936
    ds_read_b64_tr_b16 v[48:49], v56 offset:40704
    v_mov_b32 v9, 16
    ds_write_b32 v7, v9
    s_wakeup
    s_waitcnt lgkmcnt(9)
    v_mfma_f32_32x32x16_bf16 v[96:111], v[34:37], v[10:13], v[96:111]
    v_mfma_f32_32x32x16_bf16 v[144:159], v[34:37], v[14:17], v[144:159]
    s_waitcnt lgkmcnt(6)
    v_mfma_f32_32x32x16_bf16 v[64:79], v[38:41], v[18:21], v[64:79]
    s_waitcnt lgkmcnt(5)
    v_mfma_f32_32x32x16_bf16 v[112:127], v[38:41], v[22:25], v[112:127]
    s_waitcnt lgkmcnt(3)
    v_mfma_f32_32x32x16_bf16 v[80:95], v[42:45], v[18:21], v[80:95]
    v_mfma_f32_32x32x16_bf16 v[128:143], v[42:45], v[22:25], v[128:143]
    s_waitcnt lgkmcnt(1)
    v_mfma_f32_32x32x16_bf16 v[96:111], v[46:49], v[18:21], v[96:111]
    v_mfma_f32_32x32x16_bf16 v[144:159], v[46:49], v[22:25], v[144:159]
    s_setprio 0
    s_cmp_le_i32 s62, 0
    s_cbranch_scc1 M_EPX
    s_nop 0
    v_cvt_pk_bf16_f32 v64, 0, v64
    v_cvt_pk_bf16_f32 v65, 0, v65
    v_cvt_pk_bf16_f32 v66, 0, v66
    v_cvt_pk_bf16_f32 v67, 0, v67
    v_cvt_pk_bf16_f32 v68, 0, v68
    v_cvt_pk_bf16_f32 v69, 0, v69
    v_cvt_pk_bf16_f32 v70, 0, v70
    v_cvt_pk_bf16_f32 v71, 0, v71
    v_pk_mul_f32 v[10:11], v[64:65], v[64:65]
    v_pk_mul_f32 v[12:13], v[66:67], v[66:67]
    v_pk_mul_f32 v[14:15], v[68:69], v[68:69]
    v_pk_mul_f32 v[16:17], v[70:71], v[70:71]
    v_pk_fma_f32 v[10:11], v[10:11], s[58:59], v[4:5]
    v_pk_fma_f32 v[12:13], v[12:13], s[58:59], v[4:5]
    v_pk_fma_f32 v[14:15], v[14:15], s[58:59], v[4:5]
    v_pk_fma_f32 v[16:17], v[16:17], s[58:59], v[4:5]
    v_pk_mul_f32 v[10:11], v[10:11], v[64:65]
    v_pk_mul_f32 v[12:13], v[12:13], v[66:67]
    v_pk_mul_f32 v[14:15], v[14:15], v[68:69]
    v_pk_mul_f32 v[16:17], v[16:17], v[70:71]
    v_exp_f32 v10, v10
    v_cvt_pk_bf16_f32 v72, 0, v72
    v_exp_f32 v11, v11
    v_cvt_pk_bf16_f32 v73, 0, v73
    v_exp_f32 v12, v12
    v_cvt_pk_bf16_f32 v74, 0, v74
    v_exp_f32 v13, v13
    v_cvt_pk_bf16_f32 v75, 0, v75
    v_exp_f32 v14, v14
    v_cvt_pk_bf16_f32 v76, 0, v76
    v_exp_f32 v15, v15
    v_cvt_pk_bf16_f32 v77, 0, v77
    v_exp_f32 v16, v16
    v_cvt_pk_bf16_f32 v78, 0, v78
    v_exp_f32 v17, v17
    v_cvt_pk_bf16_f32 v79, 0, v79
    v_pk_add_f32 v[10:11], v[10:11], s[60:61]
    v_pk_add_f32 v[12:13], v[12:13], s[60:61]
    v_pk_add_f32 v[14:15], v[14:15], s[60:61]
    v_pk_add_f32 v[16:17], v[16:17], s[60:61]
    v_rcp_f32 v10, v10
    v_rcp_f32 v11, v11
    v_rcp_f32 v12, v12
    v_rcp_f32 v13, v13
    v_rcp_f32 v14, v14
    v_rcp_f32 v15, v15
    v_rcp_f32 v16, v16
    v_rcp_f32 v17, v17
    v_pk_mul_f32 v[10:11], v[10:11], v[64:65]
    v_pk_mul_f32 v[12:13], v[12:13], v[66:67]
    v_pk_mul_f32 v[14:15], v[14:15], v[68:69]
    v_pk_mul_f32 v[16:17], v[16:17], v[70:71]
    v_cvt_pk_bf16_f32 v10, 0, v10
    v_cvt_pk_bf16_f32 v11, 0, v11
    v_cvt_pk_bf16_f32 v12, 0, v12
    v_cvt_pk_bf16_f32 v13, 0, v13
    v_cvt_pk_bf16_f32 v14, 0, v14
    v_cvt_pk_bf16_f32 v15, 0, v15
    v_cvt_pk_bf16_f32 v16, 0, v16
    v_cvt_pk_bf16_f32 v17, 0, v17
    v_pk_mul_f32 v[10:11], v[10:11], v[72:73]
    v_pk_mul_f32 v[12:13], v[12:13], v[74:75]
    v_pk_mul_f32 v[14:15], v[14:15], v[76:77]
    v_pk_mul_f32 v[16:17], v[16:17], v[78:79]
    v_cvt_pk_bf16_f32 v18, v10, v11
    v_cvt_pk_bf16_f32 v19, v12, v13
    v_cvt_pk_bf16_f32 v20, v14, v15
    v_cvt_pk_bf16_f32 v21, v16, v17
    buffer_store_dwordx4 v[18:21], v2, s[4:7], s63 offen offset:0 sc1
    v_cvt_pk_bf16_f32 v112, 0, v112
    v_cvt_pk_bf16_f32 v113, 0, v113
    v_cvt_pk_bf16_f32 v114, 0, v114
    v_cvt_pk_bf16_f32 v115, 0, v115
    v_cvt_pk_bf16_f32 v116, 0, v116
    v_cvt_pk_bf16_f32 v117, 0, v117
    v_cvt_pk_bf16_f32 v118, 0, v118
    v_cvt_pk_bf16_f32 v119, 0, v119
    v_pk_mul_f32 v[22:23], v[112:113], v[112:113]
    v_pk_mul_f32 v[24:25], v[114:115], v[114:115]
    v_pk_mul_f32 v[26:27], v[116:117], v[116:117]
    v_pk_mul_f32 v[28:29], v[118:119], v[118:119]
    v_pk_fma_f32 v[22:23], v[22:23], s[58:59], v[4:5]
    v_pk_fma_f32 v[24:25], v[24:25], s[58:59], v[4:5]
    v_pk_fma_f32 v[26:27], v[26:27], s[58:59], v[4:5]
    v_pk_fma_f32 v[28:29], v[28:29], s[58:59], v[4:5]
    v_pk_mul_f32 v[22:23], v[22:23], v[112:113]
    v_pk_mul_f32 v[24:25], v[24:25], v[114:115]
    v_pk_mul_f32 v[26:27], v[26:27], v[116:117]
    v_pk_mul_f32 v[28:29], v[28:29], v[118:119]
    v_exp_f32 v22, v22
    v_cvt_pk_bf16_f32 v120, 0, v120
    v_exp_f32 v23, v23
    v_cvt_pk_bf16_f32 v121, 0, v121
    v_exp_f32 v24, v24
    v_cvt_pk_bf16_f32 v122, 0, v122
    v_exp_f32 v25, v25
    v_cvt_pk_bf16_f32 v123, 0, v123
    v_exp_f32 v26, v26
    v_cvt_pk_bf16_f32 v124, 0, v124
    v_exp_f32 v27, v27
    v_cvt_pk_bf16_f32 v125, 0, v125
    v_exp_f32 v28, v28
    v_cvt_pk_bf16_f32 v126, 0, v126
    v_exp_f32 v29, v29
    v_cvt_pk_bf16_f32 v127, 0, v127
    v_pk_add_f32 v[22:23], v[22:23], s[60:61]
    v_pk_add_f32 v[24:25], v[24:25], s[60:61]
    v_pk_add_f32 v[26:27], v[26:27], s[60:61]
    v_pk_add_f32 v[28:29], v[28:29], s[60:61]
    v_rcp_f32 v22, v22
    v_rcp_f32 v23, v23
    v_rcp_f32 v24, v24
    v_rcp_f32 v25, v25
    v_rcp_f32 v26, v26
    v_rcp_f32 v27, v27
    v_rcp_f32 v28, v28
    v_rcp_f32 v29, v29
    v_pk_mul_f32 v[22:23], v[22:23], v[112:113]
    v_pk_mul_f32 v[24:25], v[24:25], v[114:115]
    v_pk_mul_f32 v[26:27], v[26:27], v[116:117]
    v_pk_mul_f32 v[28:29], v[28:29], v[118:119]
    v_cvt_pk_bf16_f32 v22, 0, v22
    v_cvt_pk_bf16_f32 v23, 0, v23
    v_cvt_pk_bf16_f32 v24, 0, v24
    v_cvt_pk_bf16_f32 v25, 0, v25
    v_cvt_pk_bf16_f32 v26, 0, v26
    v_cvt_pk_bf16_f32 v27, 0, v27
    v_cvt_pk_bf16_f32 v28, 0, v28
    v_cvt_pk_bf16_f32 v29, 0, v29
    v_pk_mul_f32 v[22:23], v[22:23], v[120:121]
    v_pk_mul_f32 v[24:25], v[24:25], v[122:123]
    v_pk_mul_f32 v[26:27], v[26:27], v[124:125]
    v_pk_mul_f32 v[28:29], v[28:29], v[126:127]
    v_cvt_pk_bf16_f32 v30, v22, v23
    v_cvt_pk_bf16_f32 v31, v24, v25
    v_cvt_pk_bf16_f32 v32, v26, v27
    v_cvt_pk_bf16_f32 v33, v28, v29
    buffer_store_dwordx4 v[30:33], v2, s[4:7], s57 offen offset:0 sc1
    s_cmp_le_i32 s62, 1
    s_cbranch_scc1 M_EPX
    v_cvt_pk_bf16_f32 v80, 0, v80
    v_cvt_pk_bf16_f32 v81, 0, v81
    v_cvt_pk_bf16_f32 v82, 0, v82
    v_cvt_pk_bf16_f32 v83, 0, v83
    v_cvt_pk_bf16_f32 v84, 0, v84
    v_cvt_pk_bf16_f32 v85, 0, v85
    v_cvt_pk_bf16_f32 v86, 0, v86
    v_cvt_pk_bf16_f32 v87, 0, v87
    v_pk_mul_f32 v[10:11], v[80:81], v[80:81]
    v_pk_mul_f32 v[12:13], v[82:83], v[82:83]
    v_pk_mul_f32 v[14:15], v[84:85], v[84:85]
    v_pk_mul_f32 v[16:17], v[86:87], v[86:87]
    v_pk_fma_f32 v[10:11], v[10:11], s[58:59], v[4:5]
    v_pk_fma_f32 v[12:13], v[12:13], s[58:59], v[4:5]
    v_pk_fma_f32 v[14:15], v[14:15], s[58:59], v[4:5]
    v_pk_fma_f32 v[16:17], v[16:17], s[58:59], v[4:5]
    v_pk_mul_f32 v[10:11], v[10:11], v[80:81]
    v_pk_mul_f32 v[12:13], v[12:13], v[82:83]
    v_pk_mul_f32 v[14:15], v[14:15], v[84:85]
    v_pk_mul_f32 v[16:17], v[16:17], v[86:87]
    v_exp_f32 v10, v10
    v_cvt_pk_bf16_f32 v88, 0, v88
    v_exp_f32 v11, v11
    v_cvt_pk_bf16_f32 v89, 0, v89
    v_exp_f32 v12, v12
    v_cvt_pk_bf16_f32 v90, 0, v90
    v_exp_f32 v13, v13
    v_cvt_pk_bf16_f32 v91, 0, v91
    v_exp_f32 v14, v14
    v_cvt_pk_bf16_f32 v92, 0, v92
    v_exp_f32 v15, v15
    v_cvt_pk_bf16_f32 v93, 0, v93
    v_exp_f32 v16, v16
    v_cvt_pk_bf16_f32 v94, 0, v94
    v_exp_f32 v17, v17
    v_cvt_pk_bf16_f32 v95, 0, v95
    v_pk_add_f32 v[10:11], v[10:11], s[60:61]
    v_pk_add_f32 v[12:13], v[12:13], s[60:61]
    v_pk_add_f32 v[14:15], v[14:15], s[60:61]
    v_pk_add_f32 v[16:17], v[16:17], s[60:61]
    v_rcp_f32 v10, v10
    v_rcp_f32 v11, v11
    v_rcp_f32 v12, v12
    v_rcp_f32 v13, v13
    v_rcp_f32 v14, v14
    v_rcp_f32 v15, v15
    v_rcp_f32 v16, v16
    v_rcp_f32 v17, v17
    v_pk_mul_f32 v[10:11], v[10:11], v[80:81]
    v_pk_mul_f32 v[12:13], v[12:13], v[82:83]
    v_pk_mul_f32 v[14:15], v[14:15], v[84:85]
    v_pk_mul_f32 v[16:17], v[16:17], v[86:87]
    v_cvt_pk_bf16_f32 v10, 0, v10
    v_cvt_pk_bf16_f32 v11, 0, v11
    v_cvt_pk_bf16_f32 v12, 0, v12
    v_cvt_pk_bf16_f32 v13, 0, v13
    v_cvt_pk_bf16_f32 v14, 0, v14
    v_cvt_pk_bf16_f32 v15, 0, v15
    v_cvt_pk_bf16_f32 v16, 0, v16
    v_cvt_pk_bf16_f32 v17, 0, v17
    v_pk_mul_f32 v[10:11], v[10:11], v[88:89]
    v_pk_mul_f32 v[12:13], v[12:13], v[90:91]
    v_pk_mul_f32 v[14:15], v[14:15], v[92:93]
    v_pk_mul_f32 v[16:17], v[16:17], v[94:95]
    v_cvt_pk_bf16_f32 v18, v10, v11
    v_cvt_pk_bf16_f32 v19, v12, v13
    v_cvt_pk_bf16_f32 v20, v14, v15
    v_cvt_pk_bf16_f32 v21, v16, v17
    buffer_store_dwordx4 v[18:21], v2, s[4:7], s63 offen offset:1024 sc1
    v_cvt_pk_bf16_f32 v128, 0, v128
    v_cvt_pk_bf16_f32 v129, 0, v129
    v_cvt_pk_bf16_f32 v130, 0, v130
    v_cvt_pk_bf16_f32 v131, 0, v131
    v_cvt_pk_bf16_f32 v132, 0, v132
    v_cvt_pk_bf16_f32 v133, 0, v133
    v_cvt_pk_bf16_f32 v134, 0, v134
    v_cvt_pk_bf16_f32 v135, 0, v135
    v_pk_mul_f32 v[22:23], v[128:129], v[128:129]
    v_pk_mul_f32 v[24:25], v[130:131], v[130:131]
    v_pk_mul_f32 v[26:27], v[132:133], v[132:133]
    v_pk_mul_f32 v[28:29], v[134:135], v[134:135]
    v_pk_fma_f32 v[22:23], v[22:23], s[58:59], v[4:5]
    v_pk_fma_f32 v[24:25], v[24:25], s[58:59], v[4:5]
    v_pk_fma_f32 v[26:27], v[26:27], s[58:59], v[4:5]
    v_pk_fma_f32 v[28:29], v[28:29], s[58:59], v[4:5]
    v_pk_mul_f32 v[22:23], v[22:23], v[128:129]
    v_pk_mul_f32 v[24:25], v[24:25], v[130:131]
    v_pk_mul_f32 v[26:27], v[26:27], v[132:133]
    v_pk_mul_f32 v[28:29], v[28:29], v[134:135]
    v_exp_f32 v22, v22
    v_cvt_pk_bf16_f32 v136, 0, v136
    v_exp_f32 v23, v23
    v_cvt_pk_bf16_f32 v137, 0, v137
    v_exp_f32 v24, v24
    v_cvt_pk_bf16_f32 v138, 0, v138
    v_exp_f32 v25, v25
    v_cvt_pk_bf16_f32 v139, 0, v139
    v_exp_f32 v26, v26
    v_cvt_pk_bf16_f32 v140, 0, v140
    v_exp_f32 v27, v27
    v_cvt_pk_bf16_f32 v141, 0, v141
    v_exp_f32 v28, v28
    v_cvt_pk_bf16_f32 v142, 0, v142
    v_exp_f32 v29, v29
    v_cvt_pk_bf16_f32 v143, 0, v143
    v_pk_add_f32 v[22:23], v[22:23], s[60:61]
    v_pk_add_f32 v[24:25], v[24:25], s[60:61]
    v_pk_add_f32 v[26:27], v[26:27], s[60:61]
    v_pk_add_f32 v[28:29], v[28:29], s[60:61]
    v_rcp_f32 v22, v22
    v_rcp_f32 v23, v23
    v_rcp_f32 v24, v24
    v_rcp_f32 v25, v25
    v_rcp_f32 v26, v26
    v_rcp_f32 v27, v27
    v_rcp_f32 v28, v28
    v_rcp_f32 v29, v29
    v_pk_mul_f32 v[22:23], v[22:23], v[128:129]
    v_pk_mul_f32 v[24:25], v[24:25], v[130:131]
    v_pk_mul_f32 v[26:27], v[26:27], v[132:133]
    v_pk_mul_f32 v[28:29], v[28:29], v[134:135]
    v_cvt_pk_bf16_f32 v22, 0, v22
    v_cvt_pk_bf16_f32 v23, 0, v23
    v_cvt_pk_bf16_f32 v24, 0, v24
    v_cvt_pk_bf16_f32 v25, 0, v25
    v_cvt_pk_bf16_f32 v26, 0, v26
    v_cvt_pk_bf16_f32 v27, 0, v27
    v_cvt_pk_bf16_f32 v28, 0, v28
    v_cvt_pk_bf16_f32 v29, 0, v29
    v_pk_mul_f32 v[22:23], v[22:23], v[136:137]
    v_pk_mul_f32 v[24:25], v[24:25], v[138:139]
    v_pk_mul_f32 v[26:27], v[26:27], v[140:141]
    v_pk_mul_f32 v[28:29], v[28:29], v[142:143]
    v_cvt_pk_bf16_f32 v30, v22, v23
    v_cvt_pk_bf16_f32 v31, v24, v25
    v_cvt_pk_bf16_f32 v32, v26, v27
    v_cvt_pk_bf16_f32 v33, v28, v29
    buffer_store_dwordx4 v[30:33], v2, s[4:7], s57 offen offset:1024 sc1
    s_cmp_le_i32 s62, 2
    s_cbranch_scc1 M_EPX
    v_cvt_pk_bf16_f32 v96, 0, v96
    v_cvt_pk_bf16_f32 v97, 0, v97
    v_cvt_pk_bf16_f32 v98, 0, v98
    v_cvt_pk_bf16_f32 v99, 0, v99
    v_cvt_pk_bf16_f32 v100, 0, v100
    v_cvt_pk_bf16_f32 v101, 0, v101
    v_cvt_pk_bf16_f32 v102, 0, v102
    v_cvt_pk_bf16_f32 v103, 0, v103
    v_pk_mul_f32 v[10:11], v[96:97], v[96:97]
    v_pk_mul_f32 v[12:13], v[98:99], v[98:99]
    v_pk_mul_f32 v[14:15], v[100:101], v[100:101]
    v_pk_mul_f32 v[16:17], v[102:103], v[102:103]
    v_pk_fma_f32 v[10:11], v[10:11], s[58:59], v[4:5]
    v_pk_fma_f32 v[12:13], v[12:13], s[58:59], v[4:5]
    v_pk_fma_f32 v[14:15], v[14:15], s[58:59], v[4:5]
    v_pk_fma_f32 v[16:17], v[16:17], s[58:59], v[4:5]
    v_pk_mul_f32 v[10:11], v[10:11], v[96:97]
    v_pk_mul_f32 v[12:13], v[12:13], v[98:99]
    v_pk_mul_f32 v[14:15], v[14:15], v[100:101]
    v_pk_mul_f32 v[16:17], v[16:17], v[102:103]
    v_exp_f32 v10, v10
    v_cvt_pk_bf16_f32 v104, 0, v104
    v_exp_f32 v11, v11
    v_cvt_pk_bf16_f32 v105, 0, v105
    v_exp_f32 v12, v12
    v_cvt_pk_bf16_f32 v106, 0, v106
    v_exp_f32 v13, v13
    v_cvt_pk_bf16_f32 v107, 0, v107
    v_exp_f32 v14, v14
    v_cvt_pk_bf16_f32 v108, 0, v108
    v_exp_f32 v15, v15
    v_cvt_pk_bf16_f32 v109, 0, v109
    v_exp_f32 v16, v16
    v_cvt_pk_bf16_f32 v110, 0, v110
    v_exp_f32 v17, v17
    v_cvt_pk_bf16_f32 v111, 0, v111
    v_pk_add_f32 v[10:11], v[10:11], s[60:61]
    v_pk_add_f32 v[12:13], v[12:13], s[60:61]
    v_pk_add_f32 v[14:15], v[14:15], s[60:61]
    v_pk_add_f32 v[16:17], v[16:17], s[60:61]
    v_rcp_f32 v10, v10
    v_rcp_f32 v11, v11
    v_rcp_f32 v12, v12
    v_rcp_f32 v13, v13
    v_rcp_f32 v14, v14
    v_rcp_f32 v15, v15
    v_rcp_f32 v16, v16
    v_rcp_f32 v17, v17
    v_pk_mul_f32 v[10:11], v[10:11], v[96:97]
    v_pk_mul_f32 v[12:13], v[12:13], v[98:99]
    v_pk_mul_f32 v[14:15], v[14:15], v[100:101]
    v_pk_mul_f32 v[16:17], v[16:17], v[102:103]
    v_cvt_pk_bf16_f32 v10, 0, v10
    v_cvt_pk_bf16_f32 v11, 0, v11
    v_cvt_pk_bf16_f32 v12, 0, v12
    v_cvt_pk_bf16_f32 v13, 0, v13
    v_cvt_pk_bf16_f32 v14, 0, v14
    v_cvt_pk_bf16_f32 v15, 0, v15
    v_cvt_pk_bf16_f32 v16, 0, v16
    v_cvt_pk_bf16_f32 v17, 0, v17
    v_pk_mul_f32 v[10:11], v[10:11], v[104:105]
    v_pk_mul_f32 v[12:13], v[12:13], v[106:107]
    v_pk_mul_f32 v[14:15], v[14:15], v[108:109]
    v_pk_mul_f32 v[16:17], v[16:17], v[110:111]
    v_cvt_pk_bf16_f32 v18, v10, v11
    v_cvt_pk_bf16_f32 v19, v12, v13
    v_cvt_pk_bf16_f32 v20, v14, v15
    v_cvt_pk_bf16_f32 v21, v16, v17
    buffer_store_dwordx4 v[18:21], v2, s[4:7], s63 offen offset:2048 sc1
    v_cvt_pk_bf16_f32 v144, 0, v144
    v_cvt_pk_bf16_f32 v145, 0, v145
    v_cvt_pk_bf16_f32 v146, 0, v146
    v_cvt_pk_bf16_f32 v147, 0, v147
    v_cvt_pk_bf16_f32 v148, 0, v148
    v_cvt_pk_bf16_f32 v149, 0, v149
    v_cvt_pk_bf16_f32 v150, 0, v150
    v_cvt_pk_bf16_f32 v151, 0, v151
    v_pk_mul_f32 v[22:23], v[144:145], v[144:145]
    v_pk_mul_f32 v[24:25], v[146:147], v[146:147]
    v_pk_mul_f32 v[26:27], v[148:149], v[148:149]
    v_pk_mul_f32 v[28:29], v[150:151], v[150:151]
    v_pk_fma_f32 v[22:23], v[22:23], s[58:59], v[4:5]
    v_pk_fma_f32 v[24:25], v[24:25], s[58:59], v[4:5]
    v_pk_fma_f32 v[26:27], v[26:27], s[58:59], v[4:5]
    v_pk_fma_f32 v[28:29], v[28:29], s[58:59], v[4:5]
    v_pk_mul_f32 v[22:23], v[22:23], v[144:145]
    v_pk_mul_f32 v[24:25], v[24:25], v[146:147]
    v_pk_mul_f32 v[26:27], v[26:27], v[148:149]
    v_pk_mul_f32 v[28:29], v[28:29], v[150:151]
    v_exp_f32 v22, v22
    v_cvt_pk_bf16_f32 v152, 0, v152
    v_exp_f32 v23, v23
    v_cvt_pk_bf16_f32 v153, 0, v153
    v_exp_f32 v24, v24
    v_cvt_pk_bf16_f32 v154, 0, v154
    v_exp_f32 v25, v25
    v_cvt_pk_bf16_f32 v155, 0, v155
    v_exp_f32 v26, v26
    v_cvt_pk_bf16_f32 v156, 0, v156
    v_exp_f32 v27, v27
    v_cvt_pk_bf16_f32 v157, 0, v157
    v_exp_f32 v28, v28
    v_cvt_pk_bf16_f32 v158, 0, v158
    v_exp_f32 v29, v29
    v_cvt_pk_bf16_f32 v159, 0, v159
    v_pk_add_f32 v[22:23], v[22:23], s[60:61]
    v_pk_add_f32 v[24:25], v[24:25], s[60:61]
    v_pk_add_f32 v[26:27], v[26:27], s[60:61]
    v_pk_add_f32 v[28:29], v[28:29], s[60:61]
    v_rcp_f32 v22, v22
    v_rcp_f32 v23, v23
    v_rcp_f32 v24, v24
    v_rcp_f32 v25, v25
    v_rcp_f32 v26, v26
    v_rcp_f32 v27, v27
    v_rcp_f32 v28, v28
    v_rcp_f32 v29, v29
    v_pk_mul_f32 v[22:23], v[22:23], v[144:145]
    v_pk_mul_f32 v[24:25], v[24:25], v[146:147]
    v_pk_mul_f32 v[26:27], v[26:27], v[148:149]
    v_pk_mul_f32 v[28:29], v[28:29], v[150:151]
    v_cvt_pk_bf16_f32 v22, 0, v22
    v_cvt_pk_bf16_f32 v23, 0, v23
    v_cvt_pk_bf16_f32 v24, 0, v24
    v_cvt_pk_bf16_f32 v25, 0, v25
    v_cvt_pk_bf16_f32 v26, 0, v26
    v_cvt_pk_bf16_f32 v27, 0, v27
    v_cvt_pk_bf16_f32 v28, 0, v28
    v_cvt_pk_bf16_f32 v29, 0, v29
    v_pk_mul_f32 v[22:23], v[22:23], v[152:153]
    v_pk_mul_f32 v[24:25], v[24:25], v[154:155]
    v_pk_mul_f32 v[26:27], v[26:27], v[156:157]
    v_pk_mul_f32 v[28:29], v[28:29], v[158:159]
    v_cvt_pk_bf16_f32 v30, v22, v23
    v_cvt_pk_bf16_f32 v31, v24, v25
    v_cvt_pk_bf16_f32 v32, v26, v27
    v_cvt_pk_bf16_f32 v33, v28, v29
    buffer_store_dwordx4 v[30:33], v2, s[4:7], s57 offen offset:2048 sc1
M_EPX:
    s_mov_b32 s63, 1
    s_and_b32 s54, s2, 7
    s_lshl_b32 s54, s54, 2
    s_bfe_u32 s52, s2, 0x20003
    s_add_u32 s54, s54, s52
    s_bfe_u32 s55, s2, 0x30005
    s_lshl_b32 s62, s24, 11
    s_add_u32 s62, s62, 57344
    v_lshrrev_b32 v16, 5, v1
    v_bfe_u32 v17, v1, 2, 2
    v_lshl_add_u32 v16, v16, 3, v17
    v_lshlrev_b32 v16, 7, v16
    v_and_b32 v17, 1, v1
    v_lshl_add_u32 v16, v17, 5, v16
    v_bfe_u32 v17, v1, 4, 1
    v_lshl_add_u32 v16, v17, 4, v16
    v_bfe_u32 v17, v1, 1, 1
    v_lshl_add_u32 v16, v17, 3, v16
    v_bfe_u32 v17, v1, 3, 1
    v_lshl_add_u32 v16, v17, 6, v16
    v_add_u32 v5, s62, v16
    v_xor_b32 v10, 64, v5
    v_add_u32 v14, 57344, v5
    v_add_u32 v15, 57344, v10
    s_mul_i32 s52, s24, 260
    s_add_u32 s53, s52, 35008
    v_mov_b32 v11, s53
    s_add_u32 s53, s52, 35008
    v_mov_b32 v12, s53
    v_mov_b32 v13, 34880
    s_mov_b32 s52, 0
M_GN1_L:
    ds_read_b32 v9, v13 offset:0
    s_add_u32 s52, s52, 1
    s_cmp_ge_u32 s52, 400000
    s_cbranch_scc1 M_GN1_X
    s_waitcnt lgkmcnt(0)
    v_cmp_gt_u32 vcc, 1, v9
    s_cbranch_vccz M_GN1_X
    s_sleep 2
    s_branch M_GN1_L
M_GN1_X:
    ds_read_b32 v6, v13 offset:28
    v_lshlrev_b32 v2, 4, v1
    s_lshl_b32 s56, s54, 1
    s_add_u32 s56, s56, 1
    s_mul_i32 s56, s56, 86
    s_mul_i32 s52, s24, 22
    s_add_u32 s56, s56, s52
    s_lshl_b32 s56, s56, 10
    s_add_u32 s56, s56, 12582912
    s_waitcnt vmcnt(0)
    v_mov_b32 v9, 1
    s_mov_b64 exec, 1
    ds_add_rtn_u32 v9, v13, v9 offset:8
    s_mov_b64 exec, -1
    s_waitcnt lgkmcnt(0)
    v_readfirstlane_b32 s52, v9
    s_cmp_eq_u32 s52, 3
    s_cbranch_scc0 M_NA
    s_lshl_b32 s53, s30, 4
    s_add_u32 s53, s53, s31
    s_lshl_b32 s53, s53, 7
    s_add_u32 s53, s53, 28311560
    s_mov_b64 exec, 1
    buffer_store_dword v6, v3, s[4:7], s53 offen sc1
    s_mov_b64 exec, -1
M_NA:
    s_mov_b32 s52, 0
M_MY_L:
    ds_read_b32 v9, v11 offset:0
    s_add_u32 s52, s52, 1
    s_cmp_ge_u32 s52, 400000
    s_cbranch_scc1 M_MY_X
    s_waitcnt lgkmcnt(0)
    v_cmp_gt_u32 vcc, 20, v9
    s_cbranch_vccz M_MY_X
    s_sleep 1
    s_branch M_MY_L
M_MY_X:
    ds_read_b64_tr_b16 v[96:97], v5 offset:32768
    ds_read_b64_tr_b16 v[98:99], v5 offset:33280
    ds_read_b64_tr_b16 v[100:101], v10 offset:32768
    ds_read_b64_tr_b16 v[102:103], v10 offset:33280
    ds_read_b64_tr_b16 v[104:105], v5 offset:40960
    ds_read_b64_tr_b16 v[106:107], v5 offset:41472
    ds_read_b64_tr_b16 v[108:109], v10 offset:40960
    ds_read_b64_tr_b16 v[110:111], v10 offset:41472
    ds_read_b64_tr_b16 v[112:113], v5 offset:49152
    ds_read_b64_tr_b16 v[114:115], v5 offset:49664
    ds_read_b64_tr_b16 v[116:117], v10 offset:49152
    ds_read_b64_tr_b16 v[118:119], v10 offset:49664
    ds_read_b64_tr_b16 v[120:121], v14 offset:0
    ds_read_b64_tr_b16 v[122:123], v14 offset:512
    ds_read_b64_tr_b16 v[124:125], v15 offset:0
    ds_read_b64_tr_b16 v[126:127], v15 offset:512
    ds_read_b64_tr_b16 v[128:129], v14 offset:8192
    ds_read_b64_tr_b16 v[130:131], v14 offset:8704
    ds_read_b64_tr_b16 v[132:133], v15 offset:8192
    ds_read_b64_tr_b16 v[134:135], v15 offset:8704
    ds_read_b64_tr_b16 v[136:137], v14 offset:16384
    ds_read_b64_tr_b16 v[138:139], v14 offset:16896
    ds_read_b64_tr_b16 v[140:141], v15 offset:16384
    ds_read_b64_tr_b16 v[142:143], v15 offset:16896
    ds_read_b64_tr_b16 v[144:145], v14 offset:24576
    ds_read_b64_tr_b16 v[146:147], v14 offset:25088
    ds_read_b64_tr_b16 v[148:149], v15 offset:24576
    ds_read_b64_tr_b16 v[150:151], v15 offset:25088
    ds_read_b64_tr_b16 v[152:153], v14 offset:32768
    ds_read_b64_tr_b16 v[154:155], v14 offset:33280
    ds_read_b64_tr_b16 v[156:157], v15 offset:32768
    ds_read_b64_tr_b16 v[158:159], v15 offset:33280
    ds_read_b64_tr_b16 v[160:161], v14 offset:40960
    ds_read_b64_tr_b16 v[162:163], v14 offset:41472
    ds_read_b64_tr_b16 v[164:165], v15 offset:40960
    ds_read_b64_tr_b16 v[166:167], v15 offset:41472
    v_mov_b32 v9, 20
    ds_write_b32 v7, v9
    s_setprio 0
    s_branch M_G2W
M_MS0:
    s_mov_b32 s52, 0
M_MT0_L:
    ds_read_b32 v60, v8 offset:0
    s_add_u32 s52, s52, 1
    s_cmp_ge_u32 s52, 400000
    s_cbranch_scc1 M_MT0_X
    s_waitcnt lgkmcnt(0)
    v_cmp_gt_u32 vcc, 2, v60
    s_cbranch_vccz M_MT0_X
    s_sleep 1
    s_branch M_MT0_L
M_MT0_X:
    s_branch M_MB0
M_MS1:
    s_mov_b32 s52, 0
M_MT1_L:
    ds_read_b32 v60, v8 offset:0
    s_add_u32 s52, s52, 1
    s_cmp_ge_u32 s52, 400000
    s_cbranch_scc1 M_MT1_X
    s_waitcnt lgkmcnt(0)
    v_cmp_gt_u32 vcc, 3, v60
    s_cbranch_vccz M_MT1_X
    s_sleep 1
    s_branch M_MT1_L
M_MT1_X:
    s_branch M_MB1
M_MS2:
    s_mov_b32 s52, 0
M_MT2_L:
    ds_read_b32 v60, v8 offset:0
    s_add_u32 s52, s52, 1
    s_cmp_ge_u32 s52, 400000
    s_cbranch_scc1 M_MT2_X
    s_waitcnt lgkmcnt(0)
    v_cmp_gt_u32 vcc, 4, v60
    s_cbranch_vccz M_MT2_X
    s_sleep 1
    s_branch M_MT2_L
M_MT2_X:
    s_branch M_MB2
M_MS3:
    s_mov_b32 s52, 0
M_MT3_L:
    ds_read_b32 v60, v8 offset:0
    s_add_u32 s52, s52, 1
    s_cmp_ge_u32 s52, 400000
    s_cbranch_scc1 M_MT3_X
    s_waitcnt lgkmcnt(0)
    v_cmp_gt_u32 vcc, 5, v60
    s_cbranch_vccz M_MT3_X
    s_sleep 1
    s_branch M_MT3_L
M_MT3_X:
    s_branch M_MB3
M_MS4:
    s_mov_b32 s52, 0
M_MT4_L:
    ds_read_b32 v60, v8 offset:0
    s_add_u32 s52, s52, 1
    s_cmp_ge_u32 s52, 400000
    s_cbranch_scc1 M_MT4_X
    s_waitcnt lgkmcnt(0)
    v_cmp_gt_u32 vcc, 6, v60
    s_cbranch_vccz M_MT4_X
    s_sleep 1
    s_branch M_MT4_L
M_MT4_X:
    s_branch M_MB4
M_MS5:
    s_mov_b32 s52, 0
M_MT5_L:
    ds_read_b32 v60, v8 offset:0
    s_add_u32 s52, s52, 1
    s_cmp_ge_u32 s52, 400000
    s_cbranch_scc1 M_MT5_X
    s_waitcnt lgkmcnt(0)
    v_cmp_gt_u32 vcc, 7, v60
    s_cbranch_vccz M_MT5_X
    s_sleep 1
    s_branch M_MT5_L
M_MT5_X:
    s_branch M_MB5
M_MS6:
    s_mov_b32 s52, 0
M_MT6_L:
    ds_read_b32 v60, v8 offset:0
    s_add_u32 s52, s52, 1
    s_cmp_ge_u32 s52, 400000
    s_cbranch_scc1 M_MT6_X
    s_waitcnt lgkmcnt(0)
    v_cmp_gt_u32 vcc, 8, v60
    s_cbranch_vccz M_MT6_X
    s_sleep 1
    s_branch M_MT6_L
M_MT6_X:
    s_branch M_MB6
M_MS7:
    s_mov_b32 s52, 0
M_MT7_L:
    ds_read_b32 v60, v8 offset:0
    s_add_u32 s52, s52, 1
    s_cmp_ge_u32 s52, 400000
    s_cbranch_scc1 M_MT7_X
    s_waitcnt lgkmcnt(0)
    v_cmp_gt_u32 vcc, 9, v60
    s_cbranch_vccz M_MT7_X
    s_sleep 1
    s_branch M_MT7_L
M_MT7_X:
    s_branch M_MB7
M_MS8:
    s_mov_b32 s52, 0
M_MT8_L:
    ds_read_b32 v60, v8 offset:0
    s_add_u32 s52, s52, 1
    s_cmp_ge_u32 s52, 400000
    s_cbranch_scc1 M_MT8_X
    s_waitcnt lgkmcnt(0)
    v_cmp_gt_u32 vcc, 10, v60
    s_cbranch_vccz M_MT8_X
    s_sleep 1
    s_branch M_MT8_L
M_MT8_X:
    s_branch M_MB8
M_MS9:
    s_mov_b32 s52, 0
M_MT9_L:
    ds_read_b32 v60, v8 offset:0
    s_add_u32 s52, s52, 1
    s_cmp_ge_u32 s52, 400000
    s_cbranch_scc1 M_MT9_X
    s_waitcnt lgkmcnt(0)
    v_cmp_gt_u32 vcc, 11, v60
    s_cbranch_vccz M_MT9_X
    s_sleep 1
    s_branch M_MT9_L
M_MT9_X:
    s_branch M_MB9
M_MS10:
    s_mov_b32 s52, 0
M_MT10_L:
    ds_read_b32 v60, v8 offset:0
    s_add_u32 s52, s52, 1
    s_cmp_ge_u32 s52, 400000
    s_cbranch_scc1 M_MT10_X
    s_waitcnt lgkmcnt(0)
    v_cmp_gt_u32 vcc, 12, v60
    s_cbranch_vccz M_MT10_X
    s_sleep 1
    s_branch M_MT10_L
M_MT10_X:
    s_branch M_MB10
M_MS11:
    s_mov_b32 s52, 0
M_MT11_L:
    ds_read_b32 v60, v8 offset:0
    s_add_u32 s52, s52, 1
    s_cmp_ge_u32 s52, 400000
    s_cbranch_scc1 M_MT11_X
    s_waitcnt lgkmcnt(0)
    v_cmp_gt_u32 vcc, 13, v60
    s_cbranch_vccz M_MT11_X
    s_sleep 1
    s_branch M_MT11_L
M_MT11_X:
    s_branch M_MB11
M_MS12:
    s_mov_b32 s52, 0
M_MT12_L:
    ds_read_b32 v60, v8 offset:0
    s_add_u32 s52, s52, 1
    s_cmp_ge_u32 s52, 400000
    s_cbranch_scc1 M_MT12_X
    s_waitcnt lgkmcnt(0)
    v_cmp_gt_u32 vcc, 14, v60
    s_cbranch_vccz M_MT12_X
    s_sleep 1
    s_branch M_MT12_L
M_MT12_X:
    s_branch M_MB12
M_MS13:
    s_mov_b32 s52, 0
M_MT13_L:
    ds_read_b32 v60, v8 offset:0
    s_add_u32 s52, s52, 1
    s_cmp_ge_u32 s52, 400000
    s_cbranch_scc1 M_MT13_X
    s_waitcnt lgkmcnt(0)
    v_cmp_gt_u32 vcc, 15, v60
    s_cbranch_vccz M_MT13_X
    s_sleep 1
    s_branch M_MT13_L
M_MT13_X:
    s_branch M_MB13
M_MS14:
    s_mov_b32 s52, 0
M_MT14_L:
    ds_read_b32 v60, v8 offset:0
    s_add_u32 s52, s52, 1
    s_cmp_ge_u32 s52, 400000
    s_cbranch_scc1 M_MT14_X
    s_waitcnt lgkmcnt(0)
    v_cmp_gt_u32 vcc, 16, v60
    s_cbranch_vccz M_MT14_X
    s_sleep 1
    s_branch M_MT14_L
M_MT14_X:
    s_branch M_MB14
M_G2L2:
    buffer_load_dwordx4 v[20:23], v2, s[4:7], s56 offen offset:0
    buffer_load_dwordx4 v[24:27], v2, s[4:7], s56 offen offset:1024
    buffer_load_dwordx4 v[28:31], v2, s[4:7], s56 offen offset:2048
    buffer_load_dwordx4 v[32:35], v2, s[4:7], s56 offen offset:3072
    s_add_u32 s53, s56, 4096
    buffer_load_dwordx4 v[36:39], v2, s[4:7], s53 offen offset:0
    buffer_load_dwordx4 v[40:43], v2, s[4:7], s53 offen offset:1024
    buffer_load_dwordx4 v[44:47], v2, s[4:7], s53 offen offset:2048
    buffer_load_dwordx4 v[48:51], v2, s[4:7], s53 offen offset:3072
    s_add_u32 s53, s56, 8192
    buffer_load_dwordx4 v[52:55], v2, s[4:7], s53 offen offset:0
    buffer_load_dwordx4 v[56:59], v2, s[4:7], s53 offen offset:1024
    buffer_load_dwordx4 v[60:63], v2, s[4:7], s53 offen offset:2048
    s_waitcnt vmcnt(10)
    v_mov_b32 v9, 21
    ds_write_b32 v7, v9
    v_mfma_f32_32x32x16_bf16 v[64:79], v[96:99], v[20:23], 0
    v_mfma_f32_32x32x16_bf16 v[80:95], v[100:103], v[20:23], 0
    s_waitcnt vmcnt(9)
    v_mfma_f32_32x32x16_bf16 v[64:79], v[104:107], v[24:27], v[64:79]
    v_mfma_f32_32x32x16_bf16 v[80:95], v[108:111], v[24:27], v[80:95]
    s_waitcnt vmcnt(8)
    v_mfma_f32_32x32x16_bf16 v[64:79], v[112:115], v[28:31], v[64:79]
    v_mfma_f32_32x32x16_bf16 v[80:95], v[116:119], v[28:31], v[80:95]
    s_waitcnt vmcnt(7)
    v_mfma_f32_32x32x16_bf16 v[64:79], v[120:123], v[32:35], v[64:79]
    v_mfma_f32_32x32x16_bf16 v[80:95], v[124:127], v[32:35], v[80:95]
    s_waitcnt vmcnt(6)
    v_mfma_f32_32x32x16_bf16 v[64:79], v[128:131], v[36:39], v[64:79]
    v_mfma_f32_32x32x16_bf16 v[80:95], v[132:135], v[36:39], v[80:95]
    s_waitcnt vmcnt(5)
    v_mfma_f32_32x32x16_bf16 v[64:79], v[136:139], v[40:43], v[64:79]
    v_mfma_f32_32x32x16_bf16 v[80:95], v[140:143], v[40:43], v[80:95]
    ds_read_b64_tr_b16 v[120:121], v5 offset:0
    ds_read_b64_tr_b16 v[122:123], v5 offset:512
    ds_read_b64_tr_b16 v[124:125], v10 offset:0
    ds_read_b64_tr_b16 v[126:127], v10 offset:512
    s_waitcnt vmcnt(4)
    v_mfma_f32_32x32x16_bf16 v[64:79], v[144:147], v[44:47], v[64:79]
    v_mfma_f32_32x32x16_bf16 v[80:95], v[148:151], v[44:47], v[80:95]
    ds_read_b64_tr_b16 v[128:129], v5 offset:8192
    ds_read_b64_tr_b16 v[130:131], v5 offset:8704
    ds_read_b64_tr_b16 v[132:133], v10 offset:8192
    ds_read_b64_tr_b16 v[134:135], v10 offset:8704
    s_waitcnt vmcnt(3)
    v_mfma_f32_32x32x16_bf16 v[64:79], v[152:155], v[48:51], v[64:79]
    v_mfma_f32_32x32x16_bf16 v[80:95], v[156:159], v[48:51], v[80:95]
    ds_read_b64_tr_b16 v[136:137], v5 offset:16384
    ds_read_b64_tr_b16 v[138:139], v5 offset:16896
    ds_read_b64_tr_b16 v[140:141], v10 offset:16384
    ds_read_b64_tr_b16 v[142:143], v10 offset:16896
    s_waitcnt vmcnt(2)
    v_mfma_f32_32x32x16_bf16 v[64:79], v[160:163], v[52:55], v[64:79]
    v_mfma_f32_32x32x16_bf16 v[80:95], v[164:167], v[52:55], v[80:95]
    ds_read_b64_tr_b16 v[144:145], v5 offset:24576
    ds_read_b64_tr_b16 v[146:147], v5 offset:25088
    ds_read_b64_tr_b16 v[148:149], v10 offset:24576
    ds_read_b64_tr_b16 v[150:151], v10 offset:25088
    s_waitcnt vmcnt(1)
    s_waitcnt lgkmcnt(12)
    v_mfma_f32_32x32x16_bf16 v[64:79], v[120:123], v[56:59], v[64:79]
    v_mfma_f32_32x32x16_bf16 v[80:95], v[124:127], v[56:59], v[80:95]
    s_mov_b32 s52, 0
M_G2VB_L:
    ds_read_b32 v9, v12 offset:0
    s_add_u32 s52, s52, 1
    s_cmp_ge_u32 s52, 400000
    s_cbranch_scc1 M_G2VB_X
    s_waitcnt lgkmcnt(0)
    v_cmp_gt_u32 vcc, 21, v9
    s_cbranch_vccnz M_G2VB_L
M_G2VB_X:
    ds_read_b64_tr_b16 v[152:153], v5 offset:32768
    ds_read_b64_tr_b16 v[154:155], v5 offset:33280
    ds_read_b64_tr_b16 v[156:157], v10 offset:32768
    ds_read_b64_tr_b16 v[158:159], v10 offset:33280
    s_waitcnt vmcnt(0)
    s_waitcnt lgkmcnt(12)
    v_mfma_f32_32x32x16_bf16 v[64:79], v[128:131], v[60:63], v[64:79]
    v_mfma_f32_32x32x16_bf16 v[80:95], v[132:135], v[60:63], v[80:95]
    buffer_load_dwordx4 v[60:63], v16, s[8:11], s58 offen
    ds_read_b64_tr_b16 v[160:161], v5 offset:40960
    ds_read_b64_tr_b16 v[162:163], v5 offset:41472
    ds_read_b64_tr_b16 v[164:165], v10 offset:40960
    ds_read_b64_tr_b16 v[166:167], v10 offset:41472
    v_lshlrev_b32 v19, 7, v1
    s_mov_b64 exec, s[90:91]
    s_mov_b32 s52, 0
M_G2P2_L:
    buffer_load_dword v4, v19, s[4:7], s60 offen sc1
    s_waitcnt vmcnt(0)
    v_cmp_ne_u32 vcc, v6, v4
    s_nop 4
    s_mov_b64 exec, vcc
    s_mov_b64 s[90:91], vcc
    s_and_b64 vcc, vcc, -1
    s_add_u32 s52, s52, 1
    s_cmp_ge_u32 s52, 100000
    s_cbranch_scc1 M_G2P2_X
    s_nop 3
    s_cmp_eq_u64 vcc, 0
    s_cbranch_scc1 M_G2P2_X
    s_sleep 1
    s_branch M_G2P2_L
M_G2P2_X:
    s_mov_b64 exec, -1
    s_add_u32 s53, s56, 8192
    buffer_load_dwordx4 v[20:23], v2, s[4:7], s53 offen offset:3072
    s_add_u32 s53, s56, 12288
    buffer_load_dwordx4 v[96:99], v2, s[4:7], s53 offen offset:0
    buffer_load_dwordx4 v[100:103], v2, s[4:7], s53 offen offset:1024
    buffer_load_dwordx4 v[24:27], v2, s[4:7], s53 offen offset:2048
    buffer_load_dwordx4 v[104:107], v2, s[4:7], s53 offen offset:3072
    s_add_u32 s53, s56, 16384
    buffer_load_dwordx4 v[108:111], v2, s[4:7], s53 offen offset:0
    buffer_load_dwordx4 v[28:31], v2, s[4:7], s53 offen offset:1024
    buffer_load_dwordx4 v[112:115], v2, s[4:7], s53 offen offset:2048
    buffer_load_dwordx4 v[116:119], v2, s[4:7], s53 offen offset:3072
    s_add_u32 s53, s56, 20480
    s_cmp_eq_u32 s24, 3
    s_cselect_b32 s52, 4096, 0
    s_sub_u32 s53, s53, s52
    buffer_load_dwordx4 v[32:35], v2, s[4:7], s53 offen offset:0
    buffer_load_dwordx4 v[36:39], v2, s[4:7], s53 offen offset:1024
    s_waitcnt vmcnt(10)
    s_waitcnt lgkmcnt(12)
    v_mfma_f32_32x32x16_bf16 v[64:79], v[136:139], v[20:23], v[64:79]
    v_mfma_f32_32x32x16_bf16 v[80:95], v[140:143], v[20:23], v[80:95]
    ds_read_b64_tr_b16 v[120:121], v5 offset:49152
    ds_read_b64_tr_b16 v[122:123], v5 offset:49664
    ds_read_b64_tr_b16 v[124:125], v10 offset:49152
    ds_read_b64_tr_b16 v[126:127], v10 offset:49664
    s_waitcnt vmcnt(9)
    s_waitcnt lgkmcnt(12)
    v_mfma_f32_32x32x16_bf16 v[64:79], v[144:147], v[96:99], v[64:79]
    v_mfma_f32_32x32x16_bf16 v[80:95], v[148:151], v[96:99], v[80:95]
    ds_read_b64_tr_b16 v[128:129], v14 offset:0
    ds_read_b64_tr_b16 v[130:131], v14 offset:512
    ds_read_b64_tr_b16 v[132:133], v15 offset:0
    ds_read_b64_tr_b16 v[134:135], v15 offset:512
    v_mov_b32 v9, 22
    ds_write_b32 v7, v9
    s_waitcnt vmcnt(8)
    s_waitcnt lgkmcnt(13)
    v_mfma_f32_32x32x16_bf16 v[64:79], v[152:155], v[100:103], v[64:79]
    v_mfma_f32_32x32x16_bf16 v[80:95], v[156:159], v[100:103], v[80:95]
    ds_read_b64_tr_b16 v[136:137], v14 offset:8192
    ds_read_b64_tr_b16 v[138:139], v14 offset:8704
    ds_read_b64_tr_b16 v[140:141], v15 offset:8192
    ds_read_b64_tr_b16 v[142:143], v15 offset:8704
    s_waitcnt vmcnt(7)
    s_waitcnt lgkmcnt(13)
    v_mfma_f32_32x32x16_bf16 v[64:79], v[160:163], v[24:27], v[64:79]
    v_mfma_f32_32x32x16_bf16 v[80:95], v[164:167], v[24:27], v[80:95]
    ds_read_b64_tr_b16 v[144:145], v14 offset:16384
    ds_read_b64_tr_b16 v[146:147], v14 offset:16896
    ds_read_b64_tr_b16 v[148:149], v15 offset:16384
    ds_read_b64_tr_b16 v[150:151], v15 offset:16896
    s_waitcnt vmcnt(6)
    s_waitcnt lgkmcnt(13)
    v_mfma_f32_32x32x16_bf16 v[64:79], v[120:123], v[104:107], v[64:79]
    v_mfma_f32_32x32x16_bf16 v[80:95], v[124:127], v[104:107], v[80:95]
    ds_read_b64_tr_b16 v[152:153], v14 offset:24576
    ds_read_b64_tr_b16 v[154:155], v14 offset:25088
    ds_read_b64_tr_b16 v[156:157], v15 offset:24576
    ds_read_b64_tr_b16 v[158:159], v15 offset:25088
    s_waitcnt vmcnt(5)
    s_waitcnt lgkmcnt(13)
    v_mfma_f32_32x32x16_bf16 v[64:79], v[128:131], v[108:111], v[64:79]
    v_mfma_f32_32x32x16_bf16 v[80:95], v[132:135], v[108:111], v[80:95]
    ds_read_b64_tr_b16 v[160:161], v14 offset:32768
    ds_read_b64_tr_b16 v[162:163], v14 offset:33280
    ds_read_b64_tr_b16 v[164:165], v15 offset:32768
    ds_read_b64_tr_b16 v[166:167], v15 offset:33280
    s_waitcnt vmcnt(4)
    s_waitcnt lgkmcnt(12)
    v_mfma_f32_32x32x16_bf16 v[64:79], v[136:139], v[28:31], v[64:79]
    v_mfma_f32_32x32x16_bf16 v[80:95], v[140:143], v[28:31], v[80:95]
    ds_read_b64_tr_b16 v[120:121], v14 offset:40960
    ds_read_b64_tr_b16 v[122:123], v14 offset:41472
    ds_read_b64_tr_b16 v[124:125], v15 offset:40960
    ds_read_b64_tr_b16 v[126:127], v15 offset:41472
    s_waitcnt vmcnt(3)
    s_waitcnt lgkmcnt(12)
    v_mfma_f32_32x32x16_bf16 v[64:79], v[144:147], v[112:115], v[64:79]
    v_mfma_f32_32x32x16_bf16 v[80:95], v[148:151], v[112:115], v[80:95]
    s_waitcnt vmcnt(2)
    s_waitcnt lgkmcnt(8)
    v_mfma_f32_32x32x16_bf16 v[64:79], v[152:155], v[116:119], v[64:79]
    v_mfma_f32_32x32x16_bf16 v[80:95], v[156:159], v[116:119], v[80:95]
    s_waitcnt vmcnt(1)
    s_waitcnt lgkmcnt(4)
    s_cmp_eq_u32 s24, 3
    s_cbranch_scc1 M_G2E
    v_mfma_f32_32x32x16_bf16 v[64:79], v[160:163], v[32:35], v[64:79]
    v_mfma_f32_32x32x16_bf16 v[80:95], v[164:167], v[32:35], v[80:95]
    s_waitcnt vmcnt(0)
    s_waitcnt lgkmcnt(0)
    v_mfma_f32_32x32x16_bf16 v[64:79], v[120:123], v[36:39], v[64:79]
    v_mfma_f32_32x32x16_bf16 v[80:95], v[124:127], v[36:39], v[80:95]
    s_branch M_G2E
M_C0:
    s_lshl_b32 s53, s24, 12
    s_add_u32 s53, s53, 18440
    v_lshl_add_u32 v4, v1, 3, s53
    ds_write_b64 v4, v[8:9] offset:0
    ds_write_b64 v4, v[12:13] offset:512
    ds_write_b64 v4, v[28:29] offset:1024
    ds_write_b64 v4, v[14:15] offset:1536
    ds_write_b64 v4, v[20:21] offset:2048
    ds_write_b64 v4, v[16:17] offset:2560
    ds_write_b64 v4, v[18:19] offset:3072
    ds_write_b64 v4, v[22:23] offset:3584
    s_sub_u32 s53, 4, s24
    s_and_b32 s53, s53, 3
    s_lshl_b32 s53, s53, 12
    s_add_u32 s53, s53, 18944
    s_cmp_eq_u32 s24, 0
    s_cselect_b32 s52, 8, 0
    s_add_u32 s53, s53, s52
    v_lshlrev_b32 v5, 3, v1
    v_sub_u32 v5, s53, v5
    s_add_u32 s53, s62, 2097152
    buffer_load_dwordx4 v[72:75], v93, s[4:7], s53 offen offset:0 sc1
    buffer_load_dwordx4 v[76:79], v93, s[4:7], s53 offen offset:1024 sc1
    s_add_u32 s53, s62, 2105344
    buffer_load_dwordx4 v[116:119], v93, s[4:7], s53 offen offset:0 sc1
    buffer_load_dwordx4 v[120:123], v93, s[4:7], s53 offen offset:1024 sc1
    s_add_u32 s53, s62, 2113536
    buffer_load_dwordx4 v[124:127], v93, s[4:7], s53 offen offset:0 sc1
    buffer_load_dwordx4 v[128:131], v93, s[4:7], s53 offen offset:1024 sc1
    v_mov_b32 v99, 1
    s_mov_b64 exec, 1
    ds_add_rtn_u32 v99, v98, v99 offset:4
    s_mov_b64 exec, -1
    s_waitcnt lgkmcnt(0)
    v_readfirstlane_b32 s52, v99
    s_cmp_eq_u32 s52, 3
    s_cbranch_scc1 M_BC_X
    s_mov_b32 s52, 0
M_BC_L:
    ds_read_b32 v99, v98 offset:4
    s_add_u32 s52, s52, 1
    s_cmp_ge_u32 s52, 400000
    s_cbranch_scc1 M_BC_X
    s_waitcnt lgkmcnt(0)
    v_cmp_gt_u32 vcc, 4, v99
    s_cbranch_vccnz M_BC_L
M_BC_X:
    ds_read_b64 v[100:101], v5 offset:3584
    ds_read_b64 v[102:103], v5 offset:3072
    ds_read_b64 v[104:105], v5 offset:2560
    ds_read_b64 v[106:107], v5 offset:2048
    ds_read_b64 v[108:109], v5 offset:1536
    ds_read_b64 v[110:111], v5 offset:1024
    ds_read_b64 v[112:113], v5 offset:512
    ds_read_b64 v[114:115], v5 offset:0
    s_mov_b32 s52, 0x34000000
    v_cmp_eq_u32 vcc, 0, v0
    s_waitcnt vmcnt(0) lgkmcnt(0)
    s_nop 0
    v_cndmask_b32 v100, v100, v8, vcc
    v_cndmask_b32 v101, v101, v9, vcc
    v_lshlrev_b32 v80, 16, v64
    v_and_b32 v81, s63, v64
    v_lshlrev_b32 v82, 16, v72
    v_and_b32 v83, s63, v72
    v_lshlrev_b32 v88, 16, v116
    v_and_b32 v89, s63, v116
    v_lshlrev_b32 v90, 16, v124
    v_and_b32 v91, s63, v124
    v_add_f32 v80, v80, v88
    v_sub_f32 v81, v81, v89
    v_add_f32 v82, v82, v90
    v_sub_f32 v83, v83, v91
    v_add_f32 v88, v80, v82
    v_add_f32 v89, v81, v83
    v_sub_f32 v90, v80, v82
    v_sub_f32 v91, v81, v83
    v_mul_f32 v80, v8, v88
    v_mul_f32 v81, v8, v89
    v_fma_f32 v80, -v9, v89, v80
    v_fma_f32 v81, v9, v88, v81
    v_fma_f32 v80, v100, v90, v80
    v_fma_f32 v81, v100, v91, v81
    v_fma_f32 v80, v101, v91, v80
    v_fma_f32 v81, -v101, v90, v81
    v_mul_f32 v8, s52, v80
    v_mul_f32 v9, s52, v81
    v_lshlrev_b32 v80, 16, v65
    v_and_b32 v81, s63, v65
    v_lshlrev_b32 v82, 16, v73
    v_and_b32 v83, s63, v73
    v_lshlrev_b32 v88, 16, v117
    v_and_b32 v89, s63, v117
    v_lshlrev_b32 v90, 16, v125
    v_and_b32 v91, s63, v125
    v_add_f32 v80, v80, v88
    v_sub_f32 v81, v81, v89
    v_add_f32 v82, v82, v90
    v_sub_f32 v83, v83, v91
    v_add_f32 v88, v80, v82
    v_add_f32 v89, v81, v83
    v_sub_f32 v90, v80, v82
    v_sub_f32 v91, v81, v83
    v_mul_f32 v80, v12, v88
    v_mul_f32 v81, v12, v89
    v_fma_f32 v80, -v13, v89, v80
    v_fma_f32 v81, v13, v88, v81
    v_fma_f32 v80, v102, v90, v80
    v_fma_f32 v81, v102, v91, v81
    v_fma_f32 v80, v103, v91, v80
    v_fma_f32 v81, -v103, v90, v81
    v_mul_f32 v12, s52, v80
    v_mul_f32 v13, s52, v81
    v_lshlrev_b32 v80, 16, v66
    v_and_b32 v81, s63, v66
    v_lshlrev_b32 v82, 16, v74
    v_and_b32 v83, s63, v74
    v_lshlrev_b32 v88, 16, v118
    v_and_b32 v89, s63, v118
    v_lshlrev_b32 v90, 16, v126
    v_and_b32 v91, s63, v126
    v_add_f32 v80, v80, v88
    v_sub_f32 v81, v81, v89
    v_add_f32 v82, v82, v90
    v_sub_f32 v83, v83, v91
    v_add_f32 v88, v80, v82
    v_add_f32 v89, v81, v83
    v_sub_f32 v90, v80, v82
    v_sub_f32 v91, v81, v83
    v_mul_f32 v80, v28, v88
    v_mul_f32 v81, v28, v89
    v_fma_f32 v80, -v29, v89, v80
    v_fma_f32 v81, v29, v88, v81
    v_fma_f32 v80, v104, v90, v80
    v_fma_f32 v81, v104, v91, v81
    v_fma_f32 v80, v105, v91, v80
    v_fma_f32 v81, -v105, v90, v81
    v_mul_f32 v28, s52, v80
    v_mul_f32 v29, s52, v81
    v_lshlrev_b32 v80, 16, v67
    v_and_b32 v81, s63, v67
    v_lshlrev_b32 v82, 16, v75
    v_and_b32 v83, s63, v75
    v_lshlrev_b32 v88, 16, v119
    v_and_b32 v89, s63, v119
    v_lshlrev_b32 v90, 16, v127
    v_and_b32 v91, s63, v127
    v_add_f32 v80, v80, v88
    v_sub_f32 v81, v81, v89
    v_add_f32 v82, v82, v90
    v_sub_f32 v83, v83, v91
    v_add_f32 v88, v80, v82
    v_add_f32 v89, v81, v83
    v_sub_f32 v90, v80, v82
    v_sub_f32 v91, v81, v83
    v_mul_f32 v80, v14, v88
    v_mul_f32 v81, v14, v89
    v_fma_f32 v80, -v15, v89, v80
    v_fma_f32 v81, v15, v88, v81
    v_fma_f32 v80, v106, v90, v80
    v_fma_f32 v81, v106, v91, v81
    v_fma_f32 v80, v107, v91, v80
    v_fma_f32 v81, -v107, v90, v81
    v_mul_f32 v14, s52, v80
    v_mul_f32 v15, s52, v81
    v_lshlrev_b32 v80, 16, v68
    v_and_b32 v81, s63, v68
    v_lshlrev_b32 v82, 16, v76
    v_and_b32 v83, s63, v76
    v_lshlrev_b32 v88, 16, v120
    v_and_b32 v89, s63, v120
    v_lshlrev_b32 v90, 16, v128
    v_and_b32 v91, s63, v128
    v_add_f32 v80, v80, v88
    v_sub_f32 v81, v81, v89
    v_add_f32 v82, v82, v90
    v_sub_f32 v83, v83, v91
    v_add_f32 v88, v80, v82
    v_add_f32 v89, v81, v83
    v_sub_f32 v90, v80, v82
    v_sub_f32 v91, v81, v83
    v_mul_f32 v80, v20, v88
    v_mul_f32 v81, v20, v89
    v_fma_f32 v80, -v21, v89, v80
    v_fma_f32 v81, v21, v88, v81
    v_fma_f32 v80, v108, v90, v80
    v_fma_f32 v81, v108, v91, v81
    v_fma_f32 v80, v109, v91, v80
    v_fma_f32 v81, -v109, v90, v81
    v_mul_f32 v20, s52, v80
    v_mul_f32 v21, s52, v81
    v_lshlrev_b32 v80, 16, v69
    v_and_b32 v81, s63, v69
    v_lshlrev_b32 v82, 16, v77
    v_and_b32 v83, s63, v77
    v_lshlrev_b32 v88, 16, v121
    v_and_b32 v89, s63, v121
    v_lshlrev_b32 v90, 16, v129
    v_and_b32 v91, s63, v129
    v_add_f32 v80, v80, v88
    v_sub_f32 v81, v81, v89
    v_add_f32 v82, v82, v90
    v_sub_f32 v83, v83, v91
    v_add_f32 v88, v80, v82
    v_add_f32 v89, v81, v83
    v_sub_f32 v90, v80, v82
    v_sub_f32 v91, v81, v83
    v_mul_f32 v80, v16, v88
    v_mul_f32 v81, v16, v89
    v_fma_f32 v80, -v17, v89, v80
    v_fma_f32 v81, v17, v88, v81
    v_fma_f32 v80, v110, v90, v80
    v_fma_f32 v81, v110, v91, v81
    v_fma_f32 v80, v111, v91, v80
    v_fma_f32 v81, -v111, v90, v81
    v_mul_f32 v16, s52, v80
    v_mul_f32 v17, s52, v81
    v_lshlrev_b32 v80, 16, v70
    v_and_b32 v81, s63, v70
    v_lshlrev_b32 v82, 16, v78
    v_and_b32 v83, s63, v78
    v_lshlrev_b32 v88, 16, v122
    v_and_b32 v89, s63, v122
    v_lshlrev_b32 v90, 16, v130
    v_and_b32 v91, s63, v130
    v_add_f32 v80, v80, v88
    v_sub_f32 v81, v81, v89
    v_add_f32 v82, v82, v90
    v_sub_f32 v83, v83, v91
    v_add_f32 v88, v80, v82
    v_add_f32 v89, v81, v83
    v_sub_f32 v90, v80, v82
    v_sub_f32 v91, v81, v83
    v_mul_f32 v80, v18, v88
    v_mul_f32 v81, v18, v89
    v_fma_f32 v80, -v19, v89, v80
    v_fma_f32 v81, v19, v88, v81
    v_fma_f32 v80, v112, v90, v80
    v_fma_f32 v81, v112, v91, v81
    v_fma_f32 v80, v113, v91, v80
    v_fma_f32 v81, -v113, v90, v81
    v_mul_f32 v18, s52, v80
    v_mul_f32 v19, s52, v81
    v_lshlrev_b32 v80, 16, v71
    v_and_b32 v81, s63, v71
    v_lshlrev_b32 v82, 16, v79
    v_and_b32 v83, s63, v79
    v_lshlrev_b32 v88, 16, v123
    v_and_b32 v89, s63, v123
    v_lshlrev_b32 v90, 16, v131
    v_and_b32 v91, s63, v131
    v_add_f32 v80, v80, v88
    v_sub_f32 v81, v81, v89
    v_add_f32 v82, v82, v90
    v_sub_f32 v83, v83, v91
    v_add_f32 v88, v80, v82
    v_add_f32 v89, v81, v83
    v_sub_f32 v90, v80, v82
    v_sub_f32 v91, v81, v83
    v_mul_f32 v80, v22, v88
    v_mul_f32 v81, v22, v89
    v_fma_f32 v80, -v23, v89, v80
    v_fma_f32 v81, v23, v88, v81
    v_fma_f32 v80, v114, v90, v80
    v_fma_f32 v81, v114, v91, v81
    v_fma_f32 v80, v115, v91, v80
    v_fma_f32 v81, -v115, v90, v81
    v_mul_f32 v22, s52, v80
    v_mul_f32 v23, s52, v81
    s_branch M_C0B
M_MSP:
    v_mov_b32 v9, 16
    ds_write_b32 v7, v9
    s_mov_b32 s63, 1
    s_and_b32 s54, s2, 7
    s_lshl_b32 s54, s54, 2
    s_bfe_u32 s52, s2, 0x20003
    s_add_u32 s54, s54, s52
    s_bfe_u32 s55, s2, 0x30005
    s_lshl_b32 s62, s24, 11
    s_add_u32 s62, s62, 57344
    v_lshrrev_b32 v16, 5, v1
    v_bfe_u32 v17, v1, 2, 2
    v_lshl_add_u32 v16, v16, 3, v17
    v_lshlrev_b32 v16, 7, v16
    v_and_b32 v17, 1, v1
    v_lshl_add_u32 v16, v17, 5, v16
    v_bfe_u32 v17, v1, 4, 1
    v_lshl_add_u32 v16, v17, 4, v16
    v_bfe_u32 v17, v1, 1, 1
    v_lshl_add_u32 v16, v17, 3, v16
    v_bfe_u32 v17, v1, 3, 1
    v_lshl_add_u32 v16, v17, 6, v16
    v_add_u32 v5, s62, v16
    v_xor_b32 v10, 64, v5
    v_add_u32 v14, 57344, v5
    v_add_u32 v15, 57344, v10
    s_mul_i32 s52, s24, 260
    s_add_u32 s53, s52, 35008
    v_mov_b32 v11, s53
    s_add_u32 s53, s52, 35008
    v_mov_b32 v12, s53
    v_mov_b32 v13, 34880
    s_mov_b32 s52, 0
M_GN2_L:
    ds_read_b32 v9, v13 offset:0
    s_add_u32 s52, s52, 1
    s_cmp_ge_u32 s52, 400000
    s_cbranch_scc1 M_GN2_X
    s_waitcnt lgkmcnt(0)
    v_cmp_gt_u32 vcc, 1, v9
    s_cbranch_vccz M_GN2_X
    s_sleep 2
    s_branch M_GN2_L
M_GN2_X:
    ds_read_b32 v6, v13 offset:28
    v_lshlrev_b32 v2, 4, v1
    s_lshl_b32 s56, s54, 1
    s_add_u32 s56, s56, 1
    s_mul_i32 s56, s56, 86
    s_mul_i32 s52, s24, 22
    s_add_u32 s56, s56, s52
    s_lshl_b32 s56, s56, 10
    s_add_u32 s56, s56, 12582912
    s_branch M_NA
M_END:
    s_endpgm
.section .rodata,"a"
.p2align 6
.amdhsa_kernel m_kernel
  .amdhsa_next_free_vgpr 168
  .amdhsa_next_free_sgpr 96
  .amdhsa_accum_offset 168
  .amdhsa_group_segment_fixed_size 0
  .amdhsa_kernarg_size 80
  .amdhsa_user_sgpr_count 2
  .amdhsa_user_sgpr_kernarg_segment_ptr 1
  .amdhsa_system_sgpr_workgroup_id_x 1
.end_amdhsa_kernel
```
